```python
import torch

def _softmax(x, axis=-1):
    return torch.softmax(x, dim=axis)
def _gelu(x):
    return torch.nn.functional.gelu(x, approximate="tanh")
def _silu(x):
    return torch.nn.functional.silu(x)
def _sigmoid(x):
    return torch.sigmoid(x)
def _layernorm(x, axis=-1, eps=1e-5):
    m = x.mean(dim=axis, keepdim=True)
    v = x.var(dim=axis, keepdim=True, unbiased=False)
    return (x - m) / torch.sqrt(v + eps)
def _scatter_add(tgt, idx, src, axis=0):
    return tgt.clone().index_add_(axis, idx, src)
def _segment_sum(src, seg, n):
    out = torch.zeros((n,) + src.shape[1:], dtype=src.dtype)
    return out.index_add_(0, seg, src)
def _pad(x, pw):
    flat = tuple(v for pair in reversed(pw) for v in pair)
    return torch.nn.functional.pad(x, flat)

kernel_name = 'concat_heads__spectral_gfnet__spectral_gfnet__prompt'

def setup_inputs():

    _w = (lambda a: (lambda t: t.to(torch.bfloat16) if t.is_floating_point() else t)(torch.as_tensor(a)))
    def _A_setup():
        B, S, D = 1, 2048, 1024
        Df = D // 2 + 1
        return {
            "x": _w((lambda *s: torch.randn(*s, dtype=torch.bfloat16) * 0.05)(B, S, D)),
            "w_r": _w((lambda *s: torch.randn(*s, dtype=torch.bfloat16) * 0.05)(S, Df) * 0.02),
            "w_i": _w((lambda *s: torch.randn(*s, dtype=torch.bfloat16) * 0.05)(S, Df) * 0.02),
        }
    _A_in = _A_setup()

    def _B_setup():
        B, S, D = 1, 2048, 1024
        Df = D // 2 + 1
        return {
            "x": _w((lambda *s: torch.randn(*s, dtype=torch.bfloat16) * 0.05)(B, S, D)),
            "w_r": _w((lambda *s: torch.randn(*s, dtype=torch.bfloat16) * 0.05)(S, Df) * 0.02),
            "w_i": _w((lambda *s: torch.randn(*s, dtype=torch.bfloat16) * 0.05)(S, Df) * 0.02),
        }
    _B_in = _B_setup()

    return {
        "A_x": _A_in["x"],
        "A_w_r": _A_in["w_r"],
        "A_w_i": _A_in["w_i"],
        "B_x": _B_in["x"],
        "B_w_r": _B_in["w_r"],
        "B_w_i": _B_in["w_i"],
    }

def reference(A_x, A_w_r, A_w_i, B_x, B_w_r, B_w_i):
    def _A_ref(x, w_r, w_i):
        B, S, D = x.shape
        X = (lambda x, axes=(-2,-1): torch.fft.rfft2(x.float(), dim=axes))(x, axes=(-2, -1))
        W = w_r + 1j * w_i
        X = X * W
        y = (lambda x, s, axes=(-2,-1): torch.fft.irfft2(x, s=s, dim=axes).to(torch.bfloat16))(X, (S, D), axes=(-2, -1))
        return y

    def _B_ref(x, w_r, w_i):
        B, S, D = x.shape
        X = (lambda x, axes=(-2,-1): torch.fft.rfft2(x.float(), dim=axes))(x, axes=(-2, -1))
        W = w_r + 1j * w_i
        X = X * W
        y = (lambda x, s, axes=(-2,-1): torch.fft.irfft2(x, s=s, dim=axes).to(torch.bfloat16))(X, (S, D), axes=(-2, -1))
        return y

    a = _A_ref(A_x, A_w_r, A_w_i)
    b = _B_ref(B_x, B_w_r, B_w_i)
    return torch.concatenate([a, b], axis=-1)
```

```asm
; @launch grid=(256,1,1) block=(512,1,1) lds=142912
.amdgcn_target "amdgcn-amd-amdhsa--gfx950"
.text
.globl concat_heads__spectral_gfnet__spectral_gfnet__prompt_kernel
.p2align 12
.p2align 8
.type concat_heads__spectral_gfnet__spectral_gfnet__prompt_kernel,@function
concat_heads__spectral_gfnet__spectral_gfnet__prompt_kernel:
    s_cmp_ge_u32 s2, 0x100
    s_cbranch_scc1 end_1
    s_bfe_u32 s30, s2, 0x10002
    s_mul_i32 s3, s30, 24
    s_load_dwordx2 s[4:5], s[0:1], s3
    s_load_dwordx2 s[24:25], s[0:1], 0x40
    s_load_dwordx2 s[20:21], s[0:1], 0x38
    s_load_dwordx2 s[8:9], s[0:1], s3 offset:8
    s_load_dwordx2 s[12:13], s[0:1], s3 offset:16
    s_load_dwordx2 s[16:17], s[0:1], 0x30
    v_lshrrev_b32 v22, 6, v0
    v_and_b32 v1, 63, v0
    v_readfirstlane_b32 s32, v22
    s_and_b32 s40, s2, 3
    s_xor_b32 s40, s40, 2
    s_lshr_b32 s41, s2, 3
    s_lshl2_add_u32 s31, s41, s40
    s_bfe_u32 s40, s31, 0x20004
    s_lshr_b32 s41, s2, 7
    s_lshl1_add_u32 s40, s40, s41
    s_xor_b32 s40, s40, 1
    s_and_b32 s41, s31, 15
    s_bfe_u32 s42, s41, 0x10001
    s_lshl1_add_u32 s34, s40, s42
    s_lshr_b32 s33, s41, 2
    s_and_b32 s42, s41, 1
    s_lshl1_add_u32 s33, s33, s42
    s_mov_b32 s6, 0x400000
    s_mov_b32 s7, 0x20000
    v_lshrrev_b32 v2, 4, v1
    v_lshlrev_b32 v4, 4, v1
    v_and_b32 v22, 8, v0
    v_lshlrev_b32 v22, 11, v22
    v_lshl_add_u32 v22, v2, 20, v22
    v_and_b32 v23, 0x70, v4
    v_add_u32 v6, v22, v23
    s_lshl4_add_u32 s40, s32, s33
    s_lshl4_add_u32 s40, s40, s34
    s_lshl_b32 s52, s40, 7
    s_add_u32 s53, s52, 0x40000
    s_add_u32 s54, s52, 0x80000
    s_add_u32 s55, s52, 0xc0000
    s_lshl3_add_u32 s100, s2, s32
    s_xor_b32 s99, s100, 9
    s_and_b32 s99, s99, 0xffffff7f
    s_lshr_b32 s98, s2, 7
    s_mov_b32 s40, 3
    s_and_b32 s41, s2, 7
    s_cselect_b32 s40, s40, 1
    s_mul_i32 s98, s98, s40
    s_cmp_lg_u32 s99, 0
    s_cbranch_scc1 ie_2
    s_bfe_u32 s42, s2, 0x10004
    s_mul_i32 s40, s42, 0x12000
    s_add_u32 s40, s40, 0x1100000
    s_xor_b32 s41, s40, 0x2000
    s_lshl_b32 s43, s42, 16
    s_add_u32 s43, s43, 0x1000000
    s_mov_b32 s26, 0x1200000
    s_mov_b32 s27, 0x20000
    s_lshl_b32 s42, s42, 3
    v_lshlrev_b32 v23, 10, v1
    v_mov_b32 v24, 0
    v_mov_b32 v32, 0
    v_mov_b32 v33, 0
    v_mov_b32 v34, 0
    v_mov_b32 v35, 0
    s_mov_b64 exec, 0
    s_branch ptouch_1
pret:
    s_mov_b64 exec, 0xff
    s_waitcnt lgkmcnt(0)
    buffer_store_dwordx4 v[32:35], v4, s[24:27], s40 offen offset:0 sc1
    buffer_store_dwordx4 v[32:35], v4, s[24:27], s40 offen offset:1536 sc1
    buffer_store_dwordx4 v[32:35], v4, s[24:27], s41 offen offset:0 sc1
    buffer_store_dwordx4 v[32:35], v4, s[24:27], s41 offen offset:1536 sc1
    s_mov_b64 exec, -1
ptouch_0:
    s_cbranch_execz pret
    buffer_store_dword v24, v23, s[24:27], s43 offen offset:0 sc1
    buffer_store_dword v24, v23, s[24:27], s43 offen offset:256 sc1
ptouch_2:
    s_cbranch_execz ptouch_0
    s_waitcnt vmcnt(4)
    s_nop 11
    s_getreg_b32 s40, hwreg(HW_REG_IB_STS, 0, 4)
ptouch_1:
    s_cbranch_execz ptouch_2
    buffer_load_dwordx4 v[80:83], v6, s[4:7], s52 offen
    buffer_load_dwordx4 v[84:87], v6, s[4:7], s53 offen
    buffer_load_dwordx4 v[88:91], v6, s[4:7], s54 offen
    buffer_load_dwordx4 v[92:95], v6, s[4:7], s55 offen
    s_max_u32 s40, s40, 2
    s_or_b32 s40, s40, 16
    s_lshl_b32 s94, s40, s42
    s_waitcnt vmcnt(4)
    s_atomic_or s94, s[20:21], 0x80
    s_branch iend_3
ie_2:
    s_mov_b64 exec, 0
    s_lshr_b32 s40, s2, 3
    s_add_u32 s40, s40, s32
    s_and_b32 s40, s40, 7
    s_cmp_eq_u32 s40, 0
    s_cbranch_scc1 stub_0
    s_cmp_eq_u32 s40, 1
    s_cbranch_scc1 stub_1
    s_cmp_eq_u32 s40, 2
    s_cbranch_scc1 stub_2
    s_cmp_eq_u32 s40, 3
    s_cbranch_scc1 stub_3
    s_cmp_eq_u32 s40, 4
    s_cbranch_scc1 stub_4
    s_cmp_eq_u32 s40, 5
    s_cbranch_scc1 stub_5
    s_cmp_eq_u32 s40, 6
    s_cbranch_scc1 stub_6
    s_branch stub_7
ret_0:
    s_mov_b64 exec, -1
    s_cmp_lg_u32 s31, 0
    s_cbranch_scc1 c_4
    s_mov_b64 exec, 0
    s_cmp_eq_u32 s32, 4
    s_cbranch_scc1 stub_8
    s_cmp_eq_u32 s32, 5
    s_cbranch_scc1 stub_9
ret_1:
    s_mov_b64 exec, -1
c_4:
    s_waitcnt lgkmcnt(0)
    s_cmp_lt_u32 s99, 8
    s_cbranch_scc1 hold_5
    s_cmp_lg_u32 s98, 0
    s_cbranch_scc1 hold_5
    buffer_load_dwordx4 v[80:83], v6, s[4:7], s52 offen
    buffer_load_dwordx4 v[84:87], v6, s[4:7], s53 offen
    buffer_load_dwordx4 v[88:91], v6, s[4:7], s54 offen
    buffer_load_dwordx4 v[92:95], v6, s[4:7], s55 offen
hold_5:
iend_3:
    s_mov_b32 s22, 256
    s_mov_b32 s23, 0x20000
    s_mov_b32 s26, 0x1200000
    s_mov_b32 s27, 0x20000
    v_and_b32 v3, 15, v1
    v_mov_b32 v18, 0
    v_mov_b32 v19, 142848
    v_lshrrev_b32 v22, 3, v1
    v_and_b32 v23, 0x30, v4
    v_lshl_add_u32 v22, v22, 6, v23
    v_and_b32 v23, 4, v1
    v_lshl_add_u32 v5, v23, 1, v22
    v_xor_b32 v22, s33, v1
    v_and_b32 v22, 1, v22
    v_mul_u32_u24 v22, 16448, v22
    v_lshl_add_u32 v22, v2, 12, v22
    v_lshl_add_u32 v22, v23, 2, v22
    v_and_b32 v23, 0x60, v5
    s_lshr_b32 s38, s32, 1
    s_and_b32 s40, s32, 1
    s_lshl2_add_u32 s38, s40, s38
    s_lshl_b32 s38, s38, 7
    v_add3_u32 v9, v22, v23, s38
    s_lshl_b32 s40, s32, 10
    s_sub_u32 s41, 0x4000, s40
    s_cmp_eq_u32 s32, 0
    s_cselect_b32 s41, 0x2000, s41
    v_add_u32 v10, s40, v5
    v_add_u32 v11, s41, v5
    s_sub_u32 s40, s99, 1
    s_cmp_ge_u32 s40, 7
    s_cbranch_scc1 held_6
    buffer_load_dwordx4 v[80:83], v6, s[4:7], s52 offen
    buffer_load_dwordx4 v[84:87], v6, s[4:7], s53 offen
    buffer_load_dwordx4 v[88:91], v6, s[4:7], s54 offen
    buffer_load_dwordx4 v[92:95], v6, s[4:7], s55 offen
held_6:
    v_cvt_f32_u32 v22, v3
    v_cvt_f32_u32 v23, v2
    v_mul_f32 v22, 0x3d800000, v22
    v_mul_f32 v23, 4.0, v23
    v_mul_f32 v24, v22, v23
    v_cos_f32 v30, v24
    v_sin_f32 v31, v24
    v_add_f32 v24, v24, v22
    v_cvt_pk_bf16_f32 v112, v30, v31
    v_cvt_pk_bf16_f32 v116, -v31, v30
    v_cos_f32 v30, v24
    v_sin_f32 v31, v24
    v_add_f32 v24, v24, v22
    v_cvt_pk_bf16_f32 v113, v30, v31
    v_cvt_pk_bf16_f32 v117, -v31, v30
    v_cos_f32 v30, v24
    v_sin_f32 v31, v24
    v_add_f32 v24, v24, v22
    v_cvt_pk_bf16_f32 v114, v30, v31
    v_cvt_pk_bf16_f32 v118, -v31, v30
    v_cos_f32 v30, v24
    v_sin_f32 v31, v24
    s_nop 0
    v_cvt_pk_bf16_f32 v115, v30, v31
    v_cvt_pk_bf16_f32 v119, -v31, v30
    s_cmp_lg_u32 s98, 1
    s_cbranch_scc1 late_7
    buffer_load_dwordx4 v[80:83], v6, s[4:7], s52 offen
    buffer_load_dwordx4 v[84:87], v6, s[4:7], s53 offen
    buffer_load_dwordx4 v[88:91], v6, s[4:7], s54 offen
    buffer_load_dwordx4 v[92:95], v6, s[4:7], s55 offen
late_7:
    s_cmp_eq_u32 s32, 0
    s_cbranch_scc1 ie_8
    v_cvt_f32_u32 v24, s32
    v_fmac_f32 v22, 0x3b800000, v24
    v_mul_f32 v24, v22, v23
    v_cos_f32 v30, v24
    v_sin_f32 v31, v24
    v_add_f32 v24, v24, v22
    v_cvt_pk_bf16_f32 v120, v30, v31
    v_cvt_pk_bf16_f32 v124, -v31, v30
    v_xor_b32 v128, 0x80000000, v120
    v_xor_b32 v132, 0x8000, v124
    v_cos_f32 v30, v24
    v_sin_f32 v31, v24
    v_add_f32 v24, v24, v22
    v_cvt_pk_bf16_f32 v121, v30, v31
    v_cvt_pk_bf16_f32 v125, -v31, v30
    v_xor_b32 v129, 0x80000000, v121
    v_xor_b32 v133, 0x8000, v125
    v_cos_f32 v30, v24
    v_sin_f32 v31, v24
    v_add_f32 v24, v24, v22
    v_cvt_pk_bf16_f32 v122, v30, v31
    v_cvt_pk_bf16_f32 v126, -v31, v30
    v_xor_b32 v130, 0x80000000, v122
    v_xor_b32 v134, 0x8000, v126
    v_cos_f32 v30, v24
    v_sin_f32 v31, v24
    s_nop 0
    v_cvt_pk_bf16_f32 v123, v30, v31
    v_cvt_pk_bf16_f32 v127, -v31, v30
    v_xor_b32 v131, 0x80000000, v123
    v_xor_b32 v135, 0x8000, v127
stub_0:
    s_cbranch_execz ret_0
    s_branch iend_9
ie_8:
    v_lshrrev_b32 v22, 1, v3
    v_cvt_f32_u32 v22, v22
    v_lshlrev_b32 v25, 31, v3
    v_add_f32 v26, 0.5, v22
    v_xor_b32 v25, 0x3d800000, v25
    v_cmp_ne_u32 vcc, 1, v3
    v_mul_f32 v22, v22, v25
    v_mul_f32 v26, v26, v25
    v_cndmask_b32 v22, 0.5, v22, vcc
    v_mul_f32 v24, v22, v23
    v_cos_f32 v30, v24
    v_sin_f32 v31, v24
    v_add_f32 v24, v24, v22
    v_cvt_pk_bf16_f32 v120, v30, v31
    v_cvt_pk_bf16_f32 v124, -v31, v30
    v_cos_f32 v30, v24
    v_sin_f32 v31, v24
    v_add_f32 v24, v24, v22
    v_cvt_pk_bf16_f32 v121, v30, v31
    v_cvt_pk_bf16_f32 v125, -v31, v30
    v_cos_f32 v30, v24
    v_sin_f32 v31, v24
    v_add_f32 v24, v24, v22
    v_cvt_pk_bf16_f32 v122, v30, v31
    v_cvt_pk_bf16_f32 v126, -v31, v30
    v_cos_f32 v30, v24
    v_sin_f32 v31, v24
    s_nop 0
    v_cvt_pk_bf16_f32 v123, v30, v31
    v_cvt_pk_bf16_f32 v127, -v31, v30
    v_mul_f32 v24, v26, v23
    v_cos_f32 v30, v24
    v_sin_f32 v31, v24
    v_add_f32 v24, v24, v26
    v_cvt_pk_bf16_f32 v128, v30, v31
    v_cvt_pk_bf16_f32 v132, -v31, v30
    v_cos_f32 v30, v24
    v_sin_f32 v31, v24
    v_add_f32 v24, v24, v26
    v_cvt_pk_bf16_f32 v129, v30, v31
    v_cvt_pk_bf16_f32 v133, -v31, v30
    v_cos_f32 v30, v24
    v_sin_f32 v31, v24
    v_add_f32 v24, v24, v26
    v_cvt_pk_bf16_f32 v130, v30, v31
    v_cvt_pk_bf16_f32 v134, -v31, v30
    v_cos_f32 v30, v24
    v_sin_f32 v31, v24
    s_nop 0
    v_cvt_pk_bf16_f32 v131, v30, v31
    v_cvt_pk_bf16_f32 v135, -v31, v30
iend_9:
    s_lshl_b32 s41, s32, 4
    s_xor_b32 s41, s41, s31
    s_lshl_b32 s41, s41, 8
    v_lshlrev_b32 v22, 4, v3
    v_lshl_add_u32 v22, v2, 10, v22
    v_xor_b32 v22, s41, v22
    v_and_b32 v23, 0x6000, v22
    v_add_u32 v22, v22, v23
    v_lshl_add_u32 v7, v2, 18, v22
    v_and_b32 v8, 0xdcff, v22
    s_bfe_u32 s40, s32, 0x10001
    s_xor_b32 s40, s40, s30
    s_bfe_u32 s42, s31, 0x10005
    s_xor_b32 s42, s42, s30
    s_lshl_b32 s46, s32, 7
    s_add_u32 s46, s46, s40
    s_lshl_b32 s46, s46, 13
    s_lshl3_add_u32 s47, s31, s42
    s_lshl_b32 s47, s47, 13
    s_mov_b32 s10, 2101248
    s_mov_b32 s11, 0x20000
    s_mov_b32 s14, 2101248
    s_mov_b32 s15, 0x20000
    s_mov_b32 s18, 0x800000
    s_mov_b32 s19, 0x20000
    s_lshr_b32 s40, s31, 4
    s_and_b32 s41, s31, 15
    s_lshl4_add_u32 s35, s41, s40
    s_and_b32 s42, s41, 12
    s_bfe_u32 s43, s41, 0x10001
    s_add_u32 s42, s42, s43
    s_and_b32 s43, s41, 1
    s_lshl1_add_u32 s42, s43, s42
    s_lshl_b32 s42, s42, 3
    s_cmp_eq_u32 s40, 0
    s_cselect_b32 s35, s42, s35
    s_cmp_eq_u32 s31, 0
    s_cselect_b32 s40, 7, 8
    s_lshl_b32 s36, s32, s40
    s_add_u32 s36, s36, s35
    s_sub_u32 s37, 0x800, s36
    s_cmp_eq_u32 s36, 0
    s_cselect_b32 s37, 0x400, s37
    s_cselect_b32 s49, 1, 0
    s_mul_i32 s36, s36, 1026
    s_mul_i32 s37, s37, 1026
    s_mul_i32 s51, s32, 4224
    s_add_u32 s51, s51, 66048
    s_and_b32 s40, s36, 2
    s_add_u32 s96, s36, s40
    s_add_u32 s97, s37, s40
    v_and_b32 v22, 17, v1
    v_bfe_u32 v29, v1, 2, 2
    v_lshl_add_u32 v22, v29, 1, v22
    v_and_b32 v29, 2, v1
    v_lshl_add_u32 v22, v29, 2, v22
    v_lshrrev_b32 v23, 5, v1
    v_lshlrev_b32 v24, 7, v23
    v_lshl_add_u32 v24, v22, 1, v24
    s_and_b32 s43, s36, 2
    s_sub_u32 s43, s51, s43
    v_add_u32 v16, s43, v24
    s_add_u32 s43, s43, 192
    v_sub_u32 v17, s43, v24
    v_cvt_f32_u32 v22, v22
    s_mul_i32 s40, s32, 4
    s_lshr_b32 s40, 0x75643120, s40
    s_and_b32 s40, s40, 7
    s_lshl_b32 s40, s40, 2
    v_lshl_add_u32 v23, v23, 1, s40
    v_mul_f32 v22, 0x3a000000, v22
    v_cvt_f32_u32 v23, v23
    v_mul_f32 v24, v23, v22
    v_cos_f32 v27, v24
    v_sin_f32 v28, v24
    v_rcp_f32 v27, v27
    v_mul_f32 v25, 0x42800000, v24
    v_mul_f32 v52, v28, v27
    v_fma_f32 v27, v52, v52, 1.0
    v_rcp_f32 v28, v27
    v_mul_f32 v26, -2.0, v52
    v_fma_f32 v27, -v27, v28, 1.0
    v_fmac_f32 v28, v27, v28
    v_mul_f32 v54, v28, v26
    v_cos_f32 v30, v25
    v_sin_f32 v31, v25
    v_add_f32 v24, v24, v22
    v_cvt_pk_bf16_f32 v48, v30, v31
    v_cvt_pk_bf16_f32 v50, -v31, v30
    v_cos_f32 v27, v24
    v_sin_f32 v28, v24
    v_rcp_f32 v27, v27
    v_mul_f32 v25, 0x42800000, v24
    v_mul_f32 v53, v28, v27
    v_fma_f32 v27, v53, v53, 1.0
    v_rcp_f32 v28, v27
    v_mul_f32 v26, -2.0, v53
    v_fma_f32 v27, -v27, v28, 1.0
    v_fmac_f32 v28, v27, v28
    v_mul_f32 v55, v28, v26
    v_cos_f32 v30, v25
    v_sin_f32 v31, v25
    s_nop 0
    v_cvt_pk_bf16_f32 v49, v30, v31
    v_cvt_pk_bf16_f32 v51, -v31, v30
    s_lshr_b32 s40, s32, 1
    s_lshl_b32 s40, s40, 7
    s_and_b32 s41, s32, 1
    s_add_u32 s40, s40, s41
    s_lshl3_add_u32 s40, s40, 126464
    v_add_u32 v22, s40, v4
    ds_write_b64 v22, v[48:49] offset:0
    ds_write_b64 v22, v[50:51] offset:4096
    ds_write_b64 v22, v[52:53] offset:8192
    ds_write_b64 v22, v[54:55] offset:12288
    s_cmp_lg_u32 s98, 3
    s_cbranch_scc1 late_10
    buffer_load_dwordx4 v[80:83], v6, s[4:7], s52 offen
    buffer_load_dwordx4 v[84:87], v6, s[4:7], s53 offen
    buffer_load_dwordx4 v[88:91], v6, s[4:7], s54 offen
    buffer_load_dwordx4 v[92:95], v6, s[4:7], s55 offen
late_10:
    s_waitcnt vmcnt(3)
    v_mov_b32 v32, v80
    v_mov_b32 v36, v81
    v_mov_b32 v40, v82
    v_mov_b32 v44, v83
    s_waitcnt vmcnt(2)
    v_mov_b32 v33, v84
    v_mov_b32 v37, v85
    v_mov_b32 v41, v86
    v_mov_b32 v45, v87
    s_waitcnt vmcnt(1)
    v_mov_b32 v34, v88
    v_mov_b32 v38, v89
    v_mov_b32 v42, v90
    v_mov_b32 v46, v91
    s_waitcnt vmcnt(0)
    v_mov_b32 v35, v92
    v_mov_b32 v39, v93
    v_mov_b32 v43, v94
stub_1:
    s_cbranch_execz ret_0
    v_mov_b32 v47, v95
    v_mfma_f32_16x16x32_bf16 v[48:51], v[112:115], v[32:35], 0
    v_mfma_f32_16x16x32_bf16 v[52:55], v[112:115], v[36:39], 0
    v_mfma_f32_16x16x32_bf16 v[56:59], v[112:115], v[40:43], 0
    v_mfma_f32_16x16x32_bf16 v[60:63], v[112:115], v[44:47], 0
    v_mfma_f32_16x16x32_bf16 v[64:67], v[116:119], v[32:35], 0
    v_mfma_f32_16x16x32_bf16 v[68:71], v[116:119], v[36:39], 0
    v_mfma_f32_16x16x32_bf16 v[72:75], v[116:119], v[40:43], 0
    v_mfma_f32_16x16x32_bf16 v[76:79], v[116:119], v[44:47], 0
    s_cmp_lg_u32 s32, 1
    s_cbranch_scc1 c_11
    buffer_load_dword v20, v18, s[20:23], 0 offen offset:128 sc1
c_11:
    s_cmp_eq_u32 s49, 1
    s_cbranch_scc1 far_12
back_13:
    v_cvt_pk_bf16_f32 v80, v48, v52
    v_cvt_pk_bf16_f32 v84, v49, v53
    v_cvt_pk_bf16_f32 v88, v50, v54
    v_cvt_pk_bf16_f32 v92, v51, v55
    v_cvt_pk_bf16_f32 v81, v56, v60
    v_cvt_pk_bf16_f32 v82, v64, v68
    v_cvt_pk_bf16_f32 v83, v72, v76
    ds_write_b128 v9, v[80:83] offset:0
    v_cvt_pk_bf16_f32 v85, v57, v61
    v_cvt_pk_bf16_f32 v86, v65, v69
    v_cvt_pk_bf16_f32 v87, v73, v77
    ds_write_b128 v9, v[84:87] offset:1024
    v_cvt_pk_bf16_f32 v89, v58, v62
    v_cvt_pk_bf16_f32 v90, v66, v70
    v_cvt_pk_bf16_f32 v91, v74, v78
    ds_write_b128 v9, v[88:91] offset:2048
    v_cvt_pk_bf16_f32 v93, v59, v63
    v_cvt_pk_bf16_f32 v94, v67, v71
    v_cvt_pk_bf16_f32 v95, v75, v79
    ds_write_b128 v9, v[92:95] offset:3072
    s_cmp_lg_u32 s32, 1
    s_cbranch_scc1 c_14
    s_mov_b32 s48, 0
sw_16:
    s_waitcnt vmcnt(0)
    v_readfirstlane_b32 s40, v20
    s_nop 0
    s_and_b32 s41, s40, 0x1010
    s_cmp_eq_u32 s41, 0x1010
    s_cbranch_scc1 swok_17
    buffer_load_dword v20, v18, s[20:23], 0 offen offset:128 sc1
    s_add_u32 s48, s48, 1
    s_cmp_lt_u32 s48, 0x80000
    s_cbranch_scc1 sw_16
    s_waitcnt vmcnt(0)
swok_17:
    s_and_b32 s41, s40, 15
    s_bfe_u32 s40, s40, 0x40008
    s_sub_i32 s42, s40, s41
    s_cmp_gt_i32 s42, 0
    s_cselect_b32 s40, 0x2000, 0
    s_abs_i32 s41, s42
    s_cmp_lt_u32 s41, 2
    s_cselect_b32 s40, 0x20000000, s40
    v_mov_b32 v20, s40
    ds_write2_b32 v19, v20, v18 offset0:0 offset1:1
c_14:
    s_waitcnt lgkmcnt(0)
    s_barrier
    ds_read_b32 v20, v19
    ds_read_b64_tr_b16 v[32:33], v10 offset:0
    ds_read_b64_tr_b16 v[34:35], v10 offset:512
    ds_read_b64_tr_b16 v[36:37], v10 offset:16448
    ds_read_b64_tr_b16 v[38:39], v10 offset:16960
    ds_read_b64_tr_b16 v[40:41], v11 offset:0
    ds_read_b64_tr_b16 v[42:43], v11 offset:512
    ds_read_b64_tr_b16 v[44:45], v11 offset:16448
    ds_read_b64_tr_b16 v[46:47], v11 offset:16960
    s_waitcnt lgkmcnt(6)
    v_mfma_f32_16x16x32_bf16 v[48:51], v[120:123], v[32:35], 0
    v_readfirstlane_b32 s99, v20
    v_mfma_f32_16x16x32_bf16 v[64:67], v[124:127], v[32:35], 0
    s_lshr_b32 s101, s99, 16
    s_waitcnt lgkmcnt(4)
    v_mfma_f32_16x16x32_bf16 v[52:55], v[120:123], v[36:39], 0
    s_and_b32 s99, s99, 0x2000
    v_mfma_f32_16x16x32_bf16 v[68:71], v[124:127], v[36:39], 0
    s_lshr_b32 s40, s46, 8
    s_waitcnt lgkmcnt(2)
    v_mfma_f32_16x16x32_bf16 v[56:59], v[128:131], v[40:43], 0
    s_and_b32 s40, s40, s101
    v_mfma_f32_16x16x32_bf16 v[72:75], v[132:135], v[40:43], 0
    s_xor_b32 s46, s46, s40
    s_waitcnt lgkmcnt(0)
    v_mfma_f32_16x16x32_bf16 v[60:63], v[128:131], v[44:47], 0
    s_xor_b32 s46, s46, s99
    v_mfma_f32_16x16x32_bf16 v[76:79], v[132:135], v[44:47], 0
    s_add_u32 s52, s46, 0x0
    s_add_u32 s53, s46, 0x10000
    s_add_u32 s54, s46, 0x20000
    s_add_u32 s55, s46, 0x30000
    s_cmp_eq_u32 s32, 0
    s_cbranch_scc1 ie_18
    v_cvt_pk_bf16_f32 v80, v48, v64
    v_cvt_pk_bf16_f32 v82, v52, v68
    v_cvt_pk_bf16_f32 v81, v56, v72
    v_cvt_pk_bf16_f32 v83, v60, v76
    buffer_store_dwordx4 v[80:83], v7, s[24:27], s52 offen sc1
    v_cvt_pk_bf16_f32 v84, v49, v65
    v_cvt_pk_bf16_f32 v86, v53, v69
    v_cvt_pk_bf16_f32 v85, v57, v73
    v_cvt_pk_bf16_f32 v87, v61, v77
    buffer_store_dwordx4 v[84:87], v7, s[24:27], s53 offen sc1
    v_cvt_pk_bf16_f32 v88, v50, v66
    v_cvt_pk_bf16_f32 v90, v54, v70
    v_cvt_pk_bf16_f32 v89, v58, v74
    v_cvt_pk_bf16_f32 v91, v62, v78
    buffer_store_dwordx4 v[88:91], v7, s[24:27], s54 offen sc1
    v_cvt_pk_bf16_f32 v92, v51, v67
    v_cvt_pk_bf16_f32 v94, v55, v71
    v_cvt_pk_bf16_f32 v93, v59, v75
    v_cvt_pk_bf16_f32 v95, v63, v79
    buffer_store_dwordx4 v[92:95], v7, s[24:27], s55 offen sc1
    s_branch iend_19
ie_18:
    v_cvt_pk_bf16_f32 v80, v48, v64
    v_cvt_pk_bf16_f32 v81, v49, v65
    v_cvt_pk_bf16_f32 v82, v52, v68
    v_cvt_pk_bf16_f32 v83, v53, v69
    buffer_store_dwordx4 v[80:83], v7, s[24:27], s52 offen sc1
    v_cvt_pk_bf16_f32 v84, v50, v66
    v_cvt_pk_bf16_f32 v85, v51, v67
    v_cvt_pk_bf16_f32 v86, v54, v70
    v_cvt_pk_bf16_f32 v87, v55, v71
    buffer_store_dwordx4 v[84:87], v7, s[24:27], s53 offen sc1
    v_cvt_pk_bf16_f32 v88, v56, v72
    v_cvt_pk_bf16_f32 v89, v57, v73
    v_cvt_pk_bf16_f32 v90, v60, v76
    v_cvt_pk_bf16_f32 v91, v61, v77
    buffer_store_dwordx4 v[88:91], v7, s[24:27], s54 offen sc1
    v_cvt_pk_bf16_f32 v92, v58, v74
    v_cvt_pk_bf16_f32 v93, v59, v75
    v_cvt_pk_bf16_f32 v94, v62, v78
    v_cvt_pk_bf16_f32 v95, v63, v79
    buffer_store_dwordx4 v[92:95], v7, s[24:27], s55 offen sc1
iend_19:
    s_lshr_b32 s41, s31, 4
    s_lshl_b32 s40, s30, 13
    s_add_u32 s40, s40, 0x1000000
    s_lshl4_add_u32 s42, s32, s41
    s_lshl_b32 s42, s42, 10
    s_add_u32 s45, s42, s40
    s_lshl4_add_u32 s42, s41, s32
    s_lshl_b32 s42, s42, 10
    s_add_u32 s44, s42, s40
    s_and_b32 s42, s31, 1
    s_lshl_b32 s42, s42, 8
    s_add_u32 s44, s44, s42
    s_lshr_b32 s40, s47, 8
    s_and_b32 s40, s40, s101
    s_xor_b32 s47, s47, s40
    s_xor_b32 s47, s47, s99
    s_xor_b32 s45, s45, s99
    s_xor_b32 s44, s44, s99
    s_mov_b32 s50, 1
    v_add_u32 v22, 126464, v4
stub_2:
    s_cbranch_execz ret_0
    ds_read_b128 v[136:139], v22 offset:0
    ds_read_b128 v[140:143], v22 offset:1024
    ds_read_b128 v[144:147], v22 offset:2048
    ds_read_b128 v[148:151], v22 offset:3072
    ds_read_b128 v[152:155], v22 offset:4096
    ds_read_b128 v[156:159], v22 offset:5120
    ds_read_b128 v[160:163], v22 offset:6144
    ds_read_b128 v[164:167], v22 offset:7168
    ds_read_b128 v[168:171], v22 offset:8192
    ds_read_b128 v[172:175], v22 offset:9216
    ds_read_b128 v[176:179], v22 offset:10240
    ds_read_b128 v[180:183], v22 offset:11264
    ds_read_b128 v[184:187], v22 offset:12288
    ds_read_b128 v[188:191], v22 offset:13312
    ds_read_b128 v[192:195], v22 offset:14336
    ds_read_b128 v[196:199], v22 offset:15360
    v_lshrrev_b32 v22, 1, v3
    v_cvt_f32_u32 v24, v2
    v_and_b32 v25, 1, v3
    v_add_f32 v24, v24, v24
    s_cmp_eq_u32 s31, 0
    s_cbranch_scc1 far_20
    v_lshl_add_u32 v23, v22, 8, s35
    v_lshlrev_b32 v26, 4, v25
    v_cvt_f32_u32 v23, v23
    v_lshlrev_b32 v28, 31, v3
    v_cvt_f32_u32 v25, v25
    v_mul_f32 v23, 0x3a000000, v23
    s_brev_b32 s40, 1
    v_lshrrev_b32 v26, v26, s40
    v_mul_f32 v27, v23, v24
    v_fmac_f32 v27, 0x3e800000, v25
    v_cos_f32 v30, v27
    v_sin_f32 v31, v27
    v_add_f32 v27, v27, v23
    v_cvt_pk_bf16_f32 v232, v30, v31
    v_cvt_pk_bf16_f32 v238, -v31, v30
    v_xor_b32 v233, v232, v26
    v_xor_b32 v239, v238, v26
    v_cos_f32 v30, v27
    v_sin_f32 v31, v27
    v_cvt_f32_u32 v22, v22
    v_cvt_pk_bf16_f32 v234, v30, v31
    v_cvt_pk_bf16_f32 v240, -v31, v30
    v_xor_b32 v235, v234, v26
    v_xor_b32 v241, v240, v26
    v_lshl_add_u32 v23, v2, 9, s35
    v_xor_b32 v22, v22, v28
    v_cvt_f32_u32 v23, v23
    v_mul_f32 v27, 0.5, v25
    v_mul_f32 v23, 0x3a000000, v23
    v_fmac_f32 v27, v23, v22
    v_cos_f32 v30, v27
    v_sin_f32 v31, v27
    v_mul_f32 v30, 0x34800000, v30
    v_mul_f32 v31, 0x34800000, v31
    v_fmac_f32 v27, 0x3e000000, v22
    v_cvt_pk_bf16_f32 v23, v30, v31
    v_cvt_pk_bf16_f32 v24, -v31, v30
    v_xor_b32 v244, v23, v28
    v_xor_b32 v248, v24, v28
    v_xor_b32 v245, v24, v28
    v_xor_b32 v249, 0x80008000, v244
    v_cos_f32 v30, v27
    v_sin_f32 v31, v27
    v_mul_f32 v30, 0x34800000, v30
    v_mul_f32 v31, 0x34800000, v31
    v_cvt_pk_bf16_f32 v23, v30, v31
    v_cvt_pk_bf16_f32 v24, -v31, v30
    v_xor_b32 v246, v23, v28
    v_xor_b32 v250, v24, v28
    v_xor_b32 v247, v24, v28
    v_xor_b32 v251, 0x80008000, v246
back_21:
    v_mov_b32 v236, v232
    v_mov_b32 v237, v233
    v_mov_b32 v242, v238
    v_mov_b32 v243, v239
    s_waitcnt vmcnt(0)
    s_atomic_add s50, s[24:25], s45 offset:0
    s_atomic_add s50, s[24:25], s45 offset:256
    s_mov_b32 s39, 0
    s_atomic_add s39, s[24:25], s44 glc
    v_mov_b32 v22, s36
    v_mov_b32 v23, s37
    s_mov_b64 vcc, 10
    v_cndmask_b32 v22, v22, v23, vcc
    v_and_b32 v23, 2, v1
    v_lshl_add_u32 v254, v23, 9, v22
    s_mov_b64 exec, 15
    buffer_load_short_d16_hi v252, v254, s[8:11], 0 offen
    buffer_load_short_d16_hi v253, v254, s[12:15], 0 offen
    s_mov_b64 exec, -1
    s_and_b32 s40, s32, 3
    s_lshr_b32 s41, s32, 2
    s_lshl1_add_u32 s43, s40, s41
    s_xor_b32 s43, s43, 1
    v_lshlrev_b32 v22, 4, v3
    v_lshl_add_u32 v22, v2, 13, v22
    s_lshl_b32 s40, s43, 9
    s_add_u32 s40, s40, 33024
    v_add_u32 v12, s40, v22
    s_lshl_b32 s40, s32, 12
    s_add_u32 s40, s40, 33024
    v_add_u32 v13, s40, v5
    v_and_b32 v22, 16, v4
    v_and_b32 v23, 2, v1
    v_bfe_u32 v24, v1, 2, 1
    v_add_u32 v23, v23, v24
    v_mul_u32_u24 v23, 8224, v23
    v_bfe_u32 v24, v1, 3, 2
    v_lshl_add_u32 v22, v24, 11, v22
    v_and_b32 v24, 32, v1
    v_add3_u32 v22, v22, v23, v24
    v_add_u32 v14, s38, v22
    s_and_b32 s40, s43, 1
    s_lshr_b32 s41, s43, 2
    s_lshl1_add_u32 s40, s41, s40
    s_lshl_b32 s40, s40, 11
    s_and_b32 s41, s43, 2
    s_mul_i32 s41, s41, 8224
    s_add_u32 s40, s40, s41
    v_add_u32 v15, s40, v5
    s_cmp_eq_u32 s49, 1
    s_cbranch_scc1 far_24
back_25:
    s_waitcnt lgkmcnt(0)
    s_bitcmp1_b32 s39, 4
    s_cbranch_scc1 pollok_23
    s_mov_b32 s48, 0
poll_22:
    s_mov_b32 s39, 0
    s_atomic_add s39, s[24:25], s44 glc
    s_add_u32 s48, s48, 1
    s_cmp_gt_u32 s48, 0x80000
    s_waitcnt lgkmcnt(0)
    s_cbranch_scc1 pollok_23
    s_bitcmp0_b32 s39, 4
    s_cbranch_scc1 poll_22
pollok_23:
    s_add_u32 s40, s47, 0x0
    buffer_load_dwordx4 v[80:83], v8, s[24:27], s40 offen offset:0 sc1
    buffer_load_dwordx4 v[84:87], v8, s[24:27], s40 offen offset:256 sc1
    buffer_load_dwordx4 v[92:95], v8, s[24:27], s40 offen offset:512 sc1
    buffer_load_dwordx4 v[96:99], v8, s[24:27], s40 offen offset:768 sc1
    s_waitcnt vmcnt(4)
    v_readlane_b32 s84, v252, 0
    v_readlane_b32 s85, v253, 0
    v_readlane_b32 s86, v252, 1
    v_readlane_b32 s87, v253, 1
    v_readlane_b32 s88, v252, 2
    v_readlane_b32 s89, v253, 2
    v_readlane_b32 s90, v252, 3
    v_readlane_b32 s91, v253, 3
    v_mov_b32 v22, s86
    v_mov_b32 v23, s87
    v_mov_b32 v24, s88
    v_mov_b32 v25, s89
    v_add_f32 v252, s84, v22
    v_sub_f32 v253, s85, v23
    v_add_f32 v254, s90, v24
    v_sub_f32 v255, s91, v25
    v_mul_f32 v252, 0.5, v252
    v_mul_f32 v253, 0.5, v253
    v_mul_f32 v254, 0.5, v254
    v_mul_f32 v255, 0.5, v255
    s_mov_b64 s[92:93], 1
    s_add_u32 m0, s51, 0
    s_nop 0
    buffer_load_dwordx4 v4, s[8:11], s96 offen  lds
    s_add_u32 m0, s51, 1056
    s_nop 0
    buffer_load_dwordx4 v4, s[12:15], s96 offen  lds
    s_mov_b32 s50, 0x10000
    s_waitcnt vmcnt(5)
    v_mov_b32 v88, v80
    v_mov_b32 v89, v81
    s_waitcnt vmcnt(4)
    v_mfma_f32_16x16x32_bf16 v[52:55], v[232:235], v[82:85], 0
    v_mfma_f32_16x16x32_bf16 v[68:71], v[238:241], v[82:85], 0
    v_mfma_f32_16x16x32_bf16 v[48:51], v[234:237], v[86:89], 0
    v_mfma_f32_16x16x32_bf16 v[64:67], v[240:243], v[86:89], 0
    s_waitcnt vmcnt(3)
    v_mov_b32 v100, v92
    v_mov_b32 v101, v93
stub_3:
    s_cbranch_execz ret_0
    s_waitcnt vmcnt(2)
    v_mfma_f32_16x16x32_bf16 v[60:63], v[232:235], v[94:97], 0
    v_cvt_pk_bf16_f32 v33, v52, v53
    v_cvt_pk_bf16_f32 v35, v68, v69
    v_mfma_f32_16x16x32_bf16 v[76:79], v[238:241], v[94:97], 0
    v_cvt_pk_bf16_f32 v32, v48, v49
    v_cvt_pk_bf16_f32 v34, v64, v65
    v_mfma_f32_16x16x32_bf16 v[56:59], v[234:237], v[98:101], 0
    ds_write_b128 v12, v[32:35] offset:0
    v_cvt_pk_bf16_f32 v37, v54, v55
    v_mfma_f32_16x16x32_bf16 v[72:75], v[240:243], v[98:101], 0
    v_cvt_pk_bf16_f32 v39, v70, v71
    v_cvt_pk_bf16_f32 v36, v50, v51
    v_cvt_pk_bf16_f32 v38, v66, v67
    ds_write_b128 v12, v[36:39] offset:4096
    v_cvt_pk_bf16_f32 v41, v60, v61
    v_cvt_pk_bf16_f32 v43, v76, v77
    v_cvt_pk_bf16_f32 v40, v56, v57
    s_nop 0
    v_cvt_pk_bf16_f32 v42, v72, v73
    ds_write_b128 v12, v[40:43] offset:256
    v_cvt_pk_bf16_f32 v45, v62, v63
    v_cvt_pk_bf16_f32 v47, v78, v79
    v_cvt_pk_bf16_f32 v44, v58, v59
    v_cvt_pk_bf16_f32 v46, v74, v75
    ds_write_b128 v12, v[44:47] offset:4352
    s_waitcnt lgkmcnt(0)
    s_barrier
    s_setprio 3
    ds_read_b64_tr_b16 v[32:33], v13 offset:0
    ds_read_b64_tr_b16 v[34:35], v13 offset:1024
    ds_read_b64_tr_b16 v[36:37], v13 offset:512
    ds_read_b64_tr_b16 v[38:39], v13 offset:1536
    ds_read_b64_tr_b16 v[40:41], v13 offset:2048
    ds_read_b64_tr_b16 v[42:43], v13 offset:3072
    ds_read_b64_tr_b16 v[44:45], v13 offset:2560
    ds_read_b64_tr_b16 v[46:47], v13 offset:3584
    s_waitcnt lgkmcnt(6)
    v_mfma_f32_32x32x16_bf16 v[48:63], v[32:35], v[136:139], 0
    s_add_u32 m0, s51, 2112
    s_nop 0
    buffer_load_dwordx4 v4, s[8:11], s97 offen  lds
    v_mfma_f32_32x32x16_bf16 v[64:79], v[32:35], v[152:155], 0
    s_waitcnt lgkmcnt(4)
    v_mfma_f32_32x32x16_bf16 v[48:63], v[36:39], v[140:143], v[48:63]
    s_add_u32 m0, s51, 3168
    s_nop 0
    buffer_load_dwordx4 v4, s[12:15], s97 offen  lds
    v_mfma_f32_32x32x16_bf16 v[64:79], v[36:39], v[156:159], v[64:79]
    s_waitcnt lgkmcnt(2)
    v_mfma_f32_32x32x16_bf16 v[48:63], v[40:43], v[144:147], v[48:63]
    v_mfma_f32_32x32x16_bf16 v[64:79], v[40:43], v[160:163], v[64:79]
    s_waitcnt lgkmcnt(0)
    v_mfma_f32_32x32x16_bf16 v[48:63], v[44:47], v[148:151], v[48:63]
    v_mfma_f32_32x32x16_bf16 v[64:79], v[44:47], v[164:167], v[64:79]
    s_setprio 2
    s_nop 10
    v_fmac_f32 v48, v168, v64
    v_fmac_f32 v49, v169, v65
    v_fmac_f32 v50, v170, v66
    v_fmac_f32 v51, v171, v67
    v_fmac_f32 v64, v184, v48
    v_fmac_f32 v65, v185, v49
    v_fmac_f32 v66, v186, v50
    v_fmac_f32 v67, v187, v51
    v_fmac_f32 v48, v168, v64
    v_fmac_f32 v49, v169, v65
    v_fmac_f32 v50, v170, v66
    v_fmac_f32 v51, v171, v67
    v_cvt_pk_bf16_f32 v32, v48, v64
    v_cvt_pk_bf16_f32 v33, v49, v65
    v_cvt_pk_bf16_f32 v34, v50, v66
    v_cvt_pk_bf16_f32 v35, v51, v67
    v_fmac_f32 v52, v172, v68
    v_fmac_f32 v53, v173, v69
    v_fmac_f32 v54, v174, v70
    v_fmac_f32 v55, v175, v71
    v_fmac_f32 v68, v188, v52
    v_fmac_f32 v69, v189, v53
    v_fmac_f32 v70, v190, v54
    v_fmac_f32 v71, v191, v55
    v_fmac_f32 v52, v172, v68
    v_fmac_f32 v53, v173, v69
    v_fmac_f32 v54, v174, v70
    v_fmac_f32 v55, v175, v71
    v_cvt_pk_bf16_f32 v36, v52, v68
    v_cvt_pk_bf16_f32 v37, v53, v69
    v_cvt_pk_bf16_f32 v38, v54, v70
    v_cvt_pk_bf16_f32 v39, v55, v71
    v_fmac_f32 v56, v176, v72
    v_fmac_f32 v57, v177, v73
    v_fmac_f32 v58, v178, v74
    v_fmac_f32 v59, v179, v75
    v_mfma_f32_32x32x16_bf16 v[80:95], v[136:139], v[32:35], 0
    v_fmac_f32 v72, v192, v56
    v_fmac_f32 v73, v193, v57
    v_fmac_f32 v74, v194, v58
    v_mfma_f32_32x32x16_bf16 v[96:111], v[152:155], v[32:35], 0
    v_fmac_f32 v75, v195, v59
    v_fmac_f32 v56, v176, v72
    v_fmac_f32 v57, v177, v73
    v_fmac_f32 v58, v178, v74
    v_fmac_f32 v59, v179, v75
    v_mfma_f32_32x32x16_bf16 v[80:95], v[140:143], v[36:39], v[80:95]
    v_cvt_pk_bf16_f32 v40, v56, v72
    v_cvt_pk_bf16_f32 v41, v57, v73
    v_cvt_pk_bf16_f32 v42, v58, v74
    v_cvt_pk_bf16_f32 v43, v59, v75
    v_fmac_f32 v60, v180, v76
    v_mfma_f32_32x32x16_bf16 v[96:111], v[156:159], v[36:39], v[96:111]
    v_fmac_f32 v61, v181, v77
    v_fmac_f32 v62, v182, v78
    v_fmac_f32 v63, v183, v79
    v_fmac_f32 v76, v196, v60
    v_fmac_f32 v77, v197, v61
    v_fmac_f32 v78, v198, v62
    v_mfma_f32_32x32x16_bf16 v[80:95], v[144:147], v[40:43], v[80:95]
    v_fmac_f32 v79, v199, v63
    v_fmac_f32 v60, v180, v76
    v_fmac_f32 v61, v181, v77
    v_fmac_f32 v62, v182, v78
    v_fmac_f32 v63, v183, v79
    v_mfma_f32_32x32x16_bf16 v[96:111], v[160:163], v[40:43], v[96:111]
    v_cvt_pk_bf16_f32 v44, v60, v76
    v_cvt_pk_bf16_f32 v45, v61, v77
    v_cvt_pk_bf16_f32 v46, v62, v78
    v_cvt_pk_bf16_f32 v47, v63, v79
    s_nop 1
    v_mfma_f32_32x32x16_bf16 v[80:95], v[148:151], v[44:47], v[80:95]
    v_mfma_f32_32x32x16_bf16 v[96:111], v[164:167], v[44:47], v[96:111]
    s_cmp_eq_u32 s49, 1
    s_cbranch_scc1 far_26
    s_setprio 1
    s_waitcnt vmcnt(2)
    ds_read_u16_d16_hi v200, v16 offset:0
    ds_read_u16_d16_hi v201, v16 offset:64
    ds_read_u16_d16_hi v202, v16 offset:512
    ds_read_u16_d16_hi v203, v16 offset:576
    ds_read_u16_d16_hi v216, v16 offset:1056
    ds_read_u16_d16_hi v217, v16 offset:1120
    ds_read_u16_d16_hi v218, v16 offset:1568
    ds_read_u16_d16_hi v219, v16 offset:1632
    s_waitcnt lgkmcnt(0)
    v_cndmask_b32 v200, v200, v252, s[92:93]
    v_cndmask_b32 v216, v216, v253, s[92:93]
    v_mul_f32 v22, v80, v200
    v_mul_f32 v23, v81, v201
    v_mul_f32 v24, v82, v202
    v_mul_f32 v25, v83, v203
    v_fma_f32 v22, -v96, v216, v22
    v_fma_f32 v23, -v97, v217, v23
    v_fma_f32 v24, -v98, v218, v24
    v_fma_f32 v25, -v99, v219, v25
    ds_read_u16_d16_hi v204, v16 offset:256
    ds_read_u16_d16_hi v205, v16 offset:320
    ds_read_u16_d16_hi v206, v16 offset:768
    v_mul_f32 v96, v96, v200
    ds_read_u16_d16_hi v207, v16 offset:832
    ds_read_u16_d16_hi v220, v16 offset:1312
    ds_read_u16_d16_hi v221, v16 offset:1376
    v_mul_f32 v97, v97, v201
    ds_read_u16_d16_hi v222, v16 offset:1824
    ds_read_u16_d16_hi v223, v16 offset:1888
    v_mul_f32 v98, v98, v202
    v_mul_f32 v99, v99, v203
stub_4:
    s_cbranch_execz ret_0
    v_fmac_f32 v96, v80, v216
    v_fmac_f32 v97, v81, v217
    v_fmac_f32 v98, v82, v218
    v_fmac_f32 v99, v83, v219
    v_cvt_pk_bf16_f32 v32, v96, v22
    v_cvt_pk_bf16_f32 v33, v97, v23
    v_cvt_pk_bf16_f32 v34, v98, v24
    v_cvt_pk_bf16_f32 v35, v99, v25
    s_waitcnt lgkmcnt(0)
    v_mul_f32 v26, v84, v204
    v_mul_f32 v27, v85, v205
    v_mul_f32 v28, v86, v206
    v_mul_f32 v29, v87, v207
    v_fma_f32 v26, -v100, v220, v26
    v_fma_f32 v27, -v101, v221, v27
    v_fma_f32 v28, -v102, v222, v28
    s_waitcnt vmcnt(0)
    ds_read_u16_d16_hi v208, v17 offset:2944
    ds_read_u16_d16_hi v209, v17 offset:2880
    ds_read_u16_d16_hi v210, v17 offset:2432
    v_fma_f32 v29, -v103, v223, v29
    v_mfma_f32_32x32x16_bf16 v[48:63], v[32:35], v[136:139], 0
    ds_read_u16_d16_hi v211, v17 offset:2368
    ds_read_u16_d16_hi v224, v17 offset:4000
    ds_read_u16_d16_hi v225, v17 offset:3936
    v_mul_f32 v100, v100, v204
    ds_read_u16_d16_hi v226, v17 offset:3488
    ds_read_u16_d16_hi v227, v17 offset:3424
    v_mul_f32 v101, v101, v205
    v_mul_f32 v102, v102, v206
    v_mul_f32 v103, v103, v207
    v_fmac_f32 v100, v84, v220
    v_fmac_f32 v101, v85, v221
    v_fmac_f32 v102, v86, v222
    v_fmac_f32 v103, v87, v223
    v_mfma_f32_32x32x16_bf16 v[64:79], v[32:35], v[152:155], 0
    v_cvt_pk_bf16_f32 v36, v100, v26
    v_cvt_pk_bf16_f32 v37, v101, v27
    v_cvt_pk_bf16_f32 v38, v102, v28
    v_cvt_pk_bf16_f32 v39, v103, v29
    s_waitcnt lgkmcnt(0)
    v_cndmask_b32 v208, v208, v254, s[92:93]
    v_cndmask_b32 v224, v224, v255, s[92:93]
    v_mul_f32 v22, v88, v208
    v_mul_f32 v23, v89, v209
    v_mul_f32 v24, v90, v210
    v_mul_f32 v25, v91, v211
    v_fmac_f32 v22, v104, v224
    v_fmac_f32 v23, v105, v225
    v_fmac_f32 v24, v106, v226
    v_fmac_f32 v25, v107, v227
    v_mfma_f32_32x32x16_bf16 v[48:63], v[36:39], v[140:143], v[48:63]
    v_mul_f32 v104, v104, v208
    v_mul_f32 v105, v105, v209
    v_mul_f32 v106, v106, v210
    v_mul_f32 v107, v107, v211
    ds_read_u16_d16_hi v212, v17 offset:2688
    ds_read_u16_d16_hi v213, v17 offset:2624
    ds_read_u16_d16_hi v214, v17 offset:2176
    v_fma_f32 v104, -v88, v224, v104
    ds_read_u16_d16_hi v215, v17 offset:2112
    ds_read_u16_d16_hi v228, v17 offset:3744
    ds_read_u16_d16_hi v229, v17 offset:3680
    v_fma_f32 v105, -v89, v225, v105
    ds_read_u16_d16_hi v230, v17 offset:3232
    ds_read_u16_d16_hi v231, v17 offset:3168
    v_fma_f32 v106, -v90, v226, v106
    v_fma_f32 v107, -v91, v227, v107
    v_mfma_f32_32x32x16_bf16 v[64:79], v[36:39], v[156:159], v[64:79]
    v_cvt_pk_bf16_f32 v40, v104, v22
    v_cvt_pk_bf16_f32 v41, v105, v23
    v_cvt_pk_bf16_f32 v42, v106, v24
    v_cvt_pk_bf16_f32 v43, v107, v25
    s_waitcnt lgkmcnt(0)
    v_mul_f32 v26, v92, v212
    v_mul_f32 v27, v93, v213
    v_mul_f32 v28, v94, v214
    v_mul_f32 v29, v95, v215
    v_fmac_f32 v26, v108, v228
    v_fmac_f32 v27, v109, v229
    v_fmac_f32 v28, v110, v230
    v_fmac_f32 v29, v111, v231
    v_mul_f32 v108, v108, v212
    v_mul_f32 v109, v109, v213
    v_mfma_f32_32x32x16_bf16 v[48:63], v[40:43], v[144:147], v[48:63]
    v_mul_f32 v110, v110, v214
    v_mul_f32 v111, v111, v215
    v_fma_f32 v108, -v92, v228, v108
    v_fma_f32 v109, -v93, v229, v109
    v_fma_f32 v110, -v94, v230, v110
    v_fma_f32 v111, -v95, v231, v111
    v_mfma_f32_32x32x16_bf16 v[64:79], v[40:43], v[160:163], v[64:79]
    v_cvt_pk_bf16_f32 v44, v108, v26
    v_cvt_pk_bf16_f32 v45, v109, v27
    v_cvt_pk_bf16_f32 v46, v110, v28
    v_cvt_pk_bf16_f32 v47, v111, v29
    s_nop 1
    v_mfma_f32_32x32x16_bf16 v[48:63], v[44:47], v[148:151], v[48:63]
    v_mfma_f32_32x32x16_bf16 v[64:79], v[44:47], v[164:167], v[64:79]
back_27:
    s_setprio 0
    s_nop 10
    v_fmac_f32 v48, v168, v64
    v_fmac_f32 v49, v169, v65
    v_fmac_f32 v50, v170, v66
    v_fmac_f32 v51, v171, v67
    v_fmac_f32 v64, v184, v48
    v_fmac_f32 v65, v185, v49
    v_fmac_f32 v66, v186, v50
    v_fmac_f32 v67, v187, v51
    v_fmac_f32 v48, v168, v64
    v_fmac_f32 v49, v169, v65
    v_fmac_f32 v50, v170, v66
    v_fmac_f32 v51, v171, v67
    v_cvt_pk_bf16_f32 v32, v48, v64
    v_cvt_pk_bf16_f32 v33, v49, v65
    v_cvt_pk_bf16_f32 v34, v50, v66
    v_cvt_pk_bf16_f32 v35, v51, v67
    v_fmac_f32 v52, v172, v68
    v_fmac_f32 v53, v173, v69
    v_fmac_f32 v54, v174, v70
    v_fmac_f32 v55, v175, v71
    v_fmac_f32 v68, v188, v52
    v_fmac_f32 v69, v189, v53
    v_fmac_f32 v70, v190, v54
    v_mfma_f32_32x32x16_bf16 v[80:95], v[32:35], v[136:139], 0
    v_fmac_f32 v71, v191, v55
    v_fmac_f32 v52, v172, v68
    v_fmac_f32 v53, v173, v69
    v_fmac_f32 v54, v174, v70
    v_fmac_f32 v55, v175, v71
    v_mfma_f32_32x32x16_bf16 v[96:111], v[32:35], v[152:155], 0
    v_cvt_pk_bf16_f32 v36, v52, v68
    v_cvt_pk_bf16_f32 v37, v53, v69
    v_cvt_pk_bf16_f32 v38, v54, v70
    v_cvt_pk_bf16_f32 v39, v55, v71
    v_fmac_f32 v56, v176, v72
    v_fmac_f32 v57, v177, v73
    v_fmac_f32 v58, v178, v74
    v_fmac_f32 v59, v179, v75
    v_fmac_f32 v72, v192, v56
    v_fmac_f32 v73, v193, v57
    v_fmac_f32 v74, v194, v58
    v_fmac_f32 v75, v195, v59
    v_mfma_f32_32x32x16_bf16 v[80:95], v[36:39], v[140:143], v[80:95]
    v_fmac_f32 v56, v176, v72
    v_fmac_f32 v57, v177, v73
    v_fmac_f32 v58, v178, v74
    v_fmac_f32 v59, v179, v75
    v_mfma_f32_32x32x16_bf16 v[96:111], v[36:39], v[156:159], v[96:111]
    v_cvt_pk_bf16_f32 v40, v56, v72
    v_cvt_pk_bf16_f32 v41, v57, v73
    v_cvt_pk_bf16_f32 v42, v58, v74
    v_cvt_pk_bf16_f32 v43, v59, v75
    v_fmac_f32 v60, v180, v76
    v_fmac_f32 v61, v181, v77
    v_fmac_f32 v62, v182, v78
    v_fmac_f32 v63, v183, v79
    v_fmac_f32 v76, v196, v60
    v_fmac_f32 v77, v197, v61
    v_fmac_f32 v78, v198, v62
    v_mfma_f32_32x32x16_bf16 v[80:95], v[40:43], v[144:147], v[80:95]
    v_fmac_f32 v79, v199, v63
    v_fmac_f32 v60, v180, v76
    v_fmac_f32 v61, v181, v77
    v_fmac_f32 v62, v182, v78
    v_fmac_f32 v63, v183, v79
    v_mfma_f32_32x32x16_bf16 v[96:111], v[40:43], v[160:163], v[96:111]
    v_cvt_pk_bf16_f32 v44, v60, v76
    v_cvt_pk_bf16_f32 v45, v61, v77
    v_cvt_pk_bf16_f32 v46, v62, v78
    v_cvt_pk_bf16_f32 v47, v63, v79
    s_nop 1
    v_mfma_f32_32x32x16_bf16 v[80:95], v[44:47], v[148:151], v[80:95]
    v_mfma_f32_32x32x16_bf16 v[96:111], v[44:47], v[164:167], v[96:111]
    s_add_u32 s52, s46, 0x800000
    s_add_u32 s53, s46, 0x810000
stub_5:
    s_cbranch_execz ret_0
    s_add_u32 s54, s46, 0x820000
    s_add_u32 s55, s46, 0x830000
    s_nop 6
    v_cvt_pk_bf16_f32 v48, v80, v82
    v_cvt_pk_bf16_f32 v49, v88, v90
    v_cvt_pk_bf16_f32 v50, v96, v98
    v_cvt_pk_bf16_f32 v51, v104, v106
    ds_write_b128 v14, v[48:51] offset:0
    v_cvt_pk_bf16_f32 v52, v84, v86
    v_cvt_pk_bf16_f32 v53, v92, v94
    v_cvt_pk_bf16_f32 v54, v100, v102
    v_cvt_pk_bf16_f32 v55, v108, v110
    ds_write_b128 v14, v[52:55] offset:1024
    v_cvt_pk_bf16_f32 v56, v81, v83
    v_cvt_pk_bf16_f32 v57, v89, v91
    v_cvt_pk_bf16_f32 v58, v97, v99
    v_cvt_pk_bf16_f32 v59, v105, v107
    ds_write_b128 v14, v[56:59] offset:64
    v_cvt_pk_bf16_f32 v60, v85, v87
    v_cvt_pk_bf16_f32 v61, v93, v95
    v_cvt_pk_bf16_f32 v62, v101, v103
    v_cvt_pk_bf16_f32 v63, v109, v111
    ds_write_b128 v14, v[60:63] offset:1088
    s_waitcnt lgkmcnt(0)
    s_barrier
    ds_read_b64_tr_b16 v[32:33], v15 offset:0
    ds_read_b64_tr_b16 v[34:35], v15 offset:512
    ds_read_b64_tr_b16 v[36:37], v15 offset:1024
    ds_read_b64_tr_b16 v[38:39], v15 offset:1536
    ds_read_b64_tr_b16 v[40:41], v15 offset:8224
    ds_read_b64_tr_b16 v[42:43], v15 offset:8736
    ds_read_b64_tr_b16 v[44:45], v15 offset:9248
    ds_read_b64_tr_b16 v[46:47], v15 offset:9760
    s_waitcnt lgkmcnt(6)
    v_mfma_f32_16x16x32_bf16 v[48:51], v[244:247], v[32:35], 0
    v_mfma_f32_16x16x32_bf16 v[64:67], v[248:251], v[32:35], 0
    s_waitcnt lgkmcnt(4)
    v_mfma_f32_16x16x32_bf16 v[52:55], v[244:247], v[36:39], 0
    v_mfma_f32_16x16x32_bf16 v[68:71], v[248:251], v[36:39], 0
    s_waitcnt lgkmcnt(2)
    v_mfma_f32_16x16x32_bf16 v[56:59], v[244:247], v[40:43], 0
    v_mfma_f32_16x16x32_bf16 v[72:75], v[248:251], v[40:43], 0
    s_nop 1
    v_cvt_pk_bf16_f32 v80, v48, v64
    v_cvt_pk_bf16_f32 v81, v49, v65
    s_waitcnt lgkmcnt(0)
    v_mfma_f32_16x16x32_bf16 v[60:63], v[244:247], v[44:47], 0
    v_cvt_pk_bf16_f32 v82, v52, v68
    v_cvt_pk_bf16_f32 v83, v53, v69
    v_mfma_f32_16x16x32_bf16 v[76:79], v[248:251], v[44:47], 0
    buffer_store_dwordx4 v[80:83], v7, s[24:27], s52 offen sc1
    v_cvt_pk_bf16_f32 v84, v50, v66
    v_cvt_pk_bf16_f32 v85, v51, v67
    v_cvt_pk_bf16_f32 v86, v54, v70
    v_cvt_pk_bf16_f32 v87, v55, v71
    buffer_store_dwordx4 v[84:87], v7, s[24:27], s53 offen sc1
    v_cvt_pk_bf16_f32 v88, v56, v72
    v_cvt_pk_bf16_f32 v89, v57, v73
    v_cvt_pk_bf16_f32 v90, v60, v76
    v_cvt_pk_bf16_f32 v91, v61, v77
    buffer_store_dwordx4 v[88:91], v7, s[24:27], s54 offen sc1
    v_cvt_pk_bf16_f32 v92, v58, v74
    v_cvt_pk_bf16_f32 v93, v59, v75
    v_cvt_pk_bf16_f32 v94, v62, v78
    v_cvt_pk_bf16_f32 v95, v63, v79
    buffer_store_dwordx4 v[92:95], v7, s[24:27], s55 offen sc1
    v_cvt_f32_u32 v22, v3
    v_mul_f32 v23, 0x3b800000, v22
    v_mul_f32 v22, 0x3d800000, v22
    s_cmp_eq_u32 s32, 0
    s_cbranch_scc1 ie_28
    v_lshl_add_u32 v24, v2, 6, s32
    v_cvt_f32_u32 v24, v24
    v_mul_f32 v24, v24, v23
    v_cos_f32 v30, v24
    v_sin_f32 v31, v24
    v_add_f32 v24, v24, v22
    v_cvt_pk_bf16_f32 v120, v30, v31
    v_cvt_pk_bf16_f32 v124, -v31, v30
    v_xor_b32 v128, 0x80000000, v120
    v_xor_b32 v132, 0x8000, v124
    v_cos_f32 v30, v24
    v_sin_f32 v31, v24
    v_add_f32 v24, v24, v22
    v_cvt_pk_bf16_f32 v121, v30, v31
    v_cvt_pk_bf16_f32 v125, -v31, v30
    v_xor_b32 v129, 0x80000000, v121
    v_xor_b32 v133, 0x8000, v125
    v_cos_f32 v30, v24
    v_sin_f32 v31, v24
    v_add_f32 v24, v24, v22
    v_cvt_pk_bf16_f32 v122, v30, v31
    v_cvt_pk_bf16_f32 v126, -v31, v30
    v_xor_b32 v130, 0x80000000, v122
    v_xor_b32 v134, 0x8000, v126
    v_cos_f32 v30, v24
    v_sin_f32 v31, v24
    s_nop 0
    v_cvt_pk_bf16_f32 v123, v30, v31
    v_cvt_pk_bf16_f32 v127, -v31, v30
    v_xor_b32 v131, 0x80000000, v123
    v_xor_b32 v135, 0x8000, v127
    s_branch iend_29
ie_28:
    v_lshlrev_b32 v24, 5, v2
    v_cvt_f32_u32 v24, v24
    v_mul_f32 v22, 0.5, v22
    v_mul_f32 v24, v24, v23
    v_cos_f32 v30, v24
    v_sin_f32 v31, v24
    v_add_f32 v24, v24, v22
    v_cvt_pk_bf16_f32 v120, v30, v31
    v_cvt_pk_bf16_f32 v124, -v31, v30
    v_xor_b32 v121, 0x80000000, v120
    v_xor_b32 v125, 0x8000, v124
    v_cos_f32 v30, v24
    v_sin_f32 v31, v24
    v_add_f32 v24, v24, v22
    v_cvt_pk_bf16_f32 v128, v30, v31
    v_cvt_pk_bf16_f32 v132, -v31, v30
    v_xor_b32 v129, 0x80000000, v128
    v_xor_b32 v133, 0x8000, v132
    v_cos_f32 v30, v24
    v_sin_f32 v31, v24
    v_add_f32 v24, v24, v22
    v_cvt_pk_bf16_f32 v122, v30, v31
    v_cvt_pk_bf16_f32 v126, -v31, v30
    v_xor_b32 v123, 0x80000000, v122
    v_xor_b32 v127, 0x8000, v126
    v_cos_f32 v30, v24
    v_sin_f32 v31, v24
    s_nop 0
    v_cvt_pk_bf16_f32 v130, v30, v31
    v_cvt_pk_bf16_f32 v134, -v31, v30
    v_xor_b32 v131, 0x80000000, v130
    v_xor_b32 v135, 0x8000, v134
    s_mov_b64 exec, 0xffff
    v_lshlrev_b32 v24, 15, v3
    v_and_b32 v24, 0x8000, v24
    v_or_b32 v121, 0x3f80, v24
    v_lshlrev_b32 v125, 16, v121
    s_mov_b64 exec, -1
iend_29:
    s_waitcnt vmcnt(0)
    s_atomic_add s50, s[24:25], s45 offset:0
    s_atomic_add s50, s[24:25], s45 offset:256
    s_mov_b32 s39, 0
    s_atomic_add s39, s[24:25], s44 glc
    v_and_b32 v22, 16, v1
    v_and_b32 v23, 33, v1
    v_lshl_add_u32 v22, v23, 5, v22
    v_and_b32 v23, 8, v1
    v_lshl_add_u32 v22, v23, 9, v22
    v_and_b32 v23, 2, v1
    v_and_b32 v24, 4, v1
stub_6:
    s_cbranch_execz ret_0
    v_mul_u32_u24 v23, 4104, v23
    v_mul_u32_u24 v24, 4112, v24
    v_add3_u32 v22, v22, v23, v24
    s_sub_u32 s42, 16, s32
    s_cmp_eq_u32 s32, 0
    s_cselect_b32 s42, 8, s42
    s_lshr_b32 s40, s32, 2
    s_and_b32 s41, s32, 1
    s_lshl1_add_u32 s40, s40, s41
    s_and_b32 s41, s32, 2
    s_lshl2_add_u32 s40, s41, s40
    s_lshl_b32 s40, s40, 6
    s_add_u32 s40, s40, 33024
    v_add_u32 v9, s40, v22
    s_lshr_b32 s40, s42, 2
    s_and_b32 s41, s42, 1
    s_lshl1_add_u32 s40, s40, s41
    s_and_b32 s41, s42, 2
    s_lshl2_add_u32 s40, s41, s40
    s_lshl_b32 s40, s40, 6
    s_add_u32 s40, s40, 33024
    v_add_u32 v10, s40, v22
    s_and_b32 s40, s32, 1
    s_mul_i32 s40, s40, 8208
    s_and_b32 s41, s32, 2
    s_mul_i32 s41, s41, 8224
    s_add_u32 s40, s40, s41
    s_and_b32 s41, s32, 4
    s_lshl_b32 s41, s41, 10
    s_add_u32 s40, s40, s41
    s_add_u32 s40, s40, 33024
    v_add_u32 v11, s40, v5
    v_and_b32 v22, 0x70, v4
    v_lshlrev_b32 v6, 1, v6
    v_sub_u32 v6, v6, v22
    s_waitcnt lgkmcnt(0)
    s_bitcmp1_b32 s39, 20
    s_cbranch_scc1 pollok_31
    s_mov_b32 s48, 0
poll_30:
    s_mov_b32 s39, 0
    s_atomic_add s39, s[24:25], s44 glc
    s_add_u32 s48, s48, 1
    s_cmp_gt_u32 s48, 0x80000
    s_waitcnt lgkmcnt(0)
    s_cbranch_scc1 pollok_31
    s_bitcmp0_b32 s39, 20
    s_cbranch_scc1 poll_30
pollok_31:
    s_add_u32 s40, s47, 0x800000
    buffer_load_dwordx4 v[80:83], v8, s[24:27], s40 offen offset:0 sc1
    buffer_load_dwordx4 v[84:87], v8, s[24:27], s40 offen offset:256 sc1
    buffer_load_dwordx4 v[88:91], v8, s[24:27], s40 offen offset:512 sc1
    buffer_load_dwordx4 v[92:95], v8, s[24:27], s40 offen offset:768 sc1
    s_lshl4_add_u32 s40, s32, s33
    s_lshl1_add_u32 s40, s40, s30
    s_lshl4_add_u32 s40, s40, s34
    s_lshl_b32 s52, s40, 7
    s_add_u32 s53, s52, 0x80000
    s_add_u32 s54, s52, 0x100000
    s_add_u32 s55, s52, 0x180000
    s_cmp_lg_u32 s32, 0
    s_cbranch_scc1 ie_32
    s_waitcnt vmcnt(3)
    v_mov_b32 v32, v80
    v_mov_b32 v33, v81
    v_mov_b32 v36, v82
    v_mov_b32 v37, v83
    s_waitcnt vmcnt(2)
    v_mov_b32 v34, v84
    v_mov_b32 v35, v85
    v_mov_b32 v38, v86
    v_mov_b32 v39, v87
    s_waitcnt vmcnt(1)
    v_mov_b32 v40, v88
    v_mov_b32 v41, v89
    v_mov_b32 v44, v90
    v_mov_b32 v45, v91
    s_waitcnt vmcnt(0)
    v_mov_b32 v42, v92
    v_mov_b32 v43, v93
    v_mov_b32 v46, v94
    v_mov_b32 v47, v95
    s_branch iend_33
ie_32:
    s_waitcnt vmcnt(3)
    v_mov_b32 v32, v80
    v_mov_b32 v36, v82
    v_mov_b32 v40, v81
    v_mov_b32 v44, v83
    s_waitcnt vmcnt(2)
    v_mov_b32 v33, v84
    v_mov_b32 v37, v86
    v_mov_b32 v41, v85
    v_mov_b32 v45, v87
    s_waitcnt vmcnt(1)
    v_mov_b32 v34, v88
    v_mov_b32 v38, v90
    v_mov_b32 v42, v89
    v_mov_b32 v46, v91
    s_waitcnt vmcnt(0)
    v_mov_b32 v35, v92
    v_mov_b32 v39, v94
    v_mov_b32 v43, v93
    v_mov_b32 v47, v95
iend_33:
    v_mfma_f32_16x16x32_bf16 v[48:51], v[32:35], v[120:123], 0
    v_mfma_f32_16x16x32_bf16 v[64:67], v[32:35], v[124:127], 0
    v_mfma_f32_16x16x32_bf16 v[52:55], v[36:39], v[120:123], 0
    v_mfma_f32_16x16x32_bf16 v[68:71], v[36:39], v[124:127], 0
    v_mfma_f32_16x16x32_bf16 v[56:59], v[40:43], v[128:131], 0
    v_mfma_f32_16x16x32_bf16 v[72:75], v[40:43], v[132:135], 0
    s_nop 2
    v_cvt_pk_bf16_f32 v80, v48, v49
    v_cvt_pk_bf16_f32 v81, v50, v51
    v_mfma_f32_16x16x32_bf16 v[60:63], v[44:47], v[128:131], 0
    v_cvt_pk_bf16_f32 v82, v64, v65
    v_cvt_pk_bf16_f32 v83, v66, v67
    v_mfma_f32_16x16x32_bf16 v[76:79], v[44:47], v[132:135], 0
    ds_write_b128 v9, v[80:83] offset:0
    v_cvt_pk_bf16_f32 v84, v52, v53
    v_cvt_pk_bf16_f32 v85, v54, v55
    v_cvt_pk_bf16_f32 v86, v68, v69
    v_cvt_pk_bf16_f32 v87, v70, v71
    ds_write_b128 v9, v[84:87] offset:2048
    v_cvt_pk_bf16_f32 v88, v56, v57
    v_cvt_pk_bf16_f32 v89, v58, v59
    v_cvt_pk_bf16_f32 v90, v72, v73
    v_cvt_pk_bf16_f32 v91, v74, v75
    ds_write_b128 v10, v[88:91] offset:0
    v_cvt_pk_bf16_f32 v92, v60, v61
    v_cvt_pk_bf16_f32 v93, v62, v63
    v_cvt_pk_bf16_f32 v94, v76, v77
    v_cvt_pk_bf16_f32 v95, v78, v79
    ds_write_b128 v10, v[92:95] offset:2048
    s_waitcnt lgkmcnt(0)
    s_barrier
    ds_read_b64_tr_b16 v[32:33], v11 offset:0
    ds_read_b64_tr_b16 v[34:35], v11 offset:512
    ds_read_b64_tr_b16 v[36:37], v11 offset:1024
    ds_read_b64_tr_b16 v[38:39], v11 offset:1536
    ds_read_b64_tr_b16 v[40:41], v11 offset:2048
    ds_read_b64_tr_b16 v[42:43], v11 offset:2560
    ds_read_b64_tr_b16 v[44:45], v11 offset:3072
    ds_read_b64_tr_b16 v[46:47], v11 offset:3584
    s_waitcnt lgkmcnt(6)
    v_mfma_f32_16x16x32_bf16 v[48:51], v[112:115], v[32:35], 0
    v_mfma_f32_16x16x32_bf16 v[64:67], v[116:119], v[32:35], 0
    s_waitcnt lgkmcnt(4)
    v_mfma_f32_16x16x32_bf16 v[52:55], v[112:115], v[36:39], 0
    v_mfma_f32_16x16x32_bf16 v[68:71], v[116:119], v[36:39], 0
    s_waitcnt lgkmcnt(2)
    v_mfma_f32_16x16x32_bf16 v[56:59], v[112:115], v[40:43], 0
    v_mfma_f32_16x16x32_bf16 v[72:75], v[116:119], v[40:43], 0
    s_waitcnt lgkmcnt(0)
    v_mfma_f32_16x16x32_bf16 v[60:63], v[112:115], v[44:47], 0
    v_mfma_f32_16x16x32_bf16 v[76:79], v[116:119], v[44:47], 0
    v_cvt_pk_bf16_f32 v80, v64, v48
    s_nop 0
    v_cvt_pk_bf16_f32 v81, v68, v52
    s_nop 1
    v_cvt_pk_bf16_f32 v82, v72, v56
    s_nop 1
    v_cvt_pk_bf16_f32 v83, v76, v60
    buffer_store_dwordx4 v[80:83], v6, s[16:19], s52 offen nt
    v_cvt_pk_bf16_f32 v84, v65, v49
    v_cvt_pk_bf16_f32 v85, v69, v53
    v_cvt_pk_bf16_f32 v86, v73, v57
    v_cvt_pk_bf16_f32 v87, v77, v61
    buffer_store_dwordx4 v[84:87], v6, s[16:19], s53 offen nt
    v_cvt_pk_bf16_f32 v88, v66, v50
    v_cvt_pk_bf16_f32 v89, v70, v54
    v_cvt_pk_bf16_f32 v90, v74, v58
    v_cvt_pk_bf16_f32 v91, v78, v62
    buffer_store_dwordx4 v[88:91], v6, s[16:19], s54 offen nt
    v_cvt_pk_bf16_f32 v92, v67, v51
    v_cvt_pk_bf16_f32 v93, v71, v55
    v_cvt_pk_bf16_f32 v94, v75, v59
stub_7:
    s_cbranch_execz ret_0
    v_cvt_pk_bf16_f32 v95, v79, v63
    buffer_store_dwordx4 v[92:95], v6, s[16:19], s55 offen nt
end_1:
    s_endpgm
far_12:
    s_add_u32 m0, s51, 0
    s_nop 0
    buffer_load_dwordx4 v4, s[8:11], s96 offen  lds
    s_add_u32 m0, s51, 1056
    s_nop 0
    buffer_load_dwordx4 v4, s[12:15], s96 offen  lds
    s_add_u32 m0, s51, 2112
    s_nop 0
    buffer_load_dwordx4 v4, s[8:11], s97 offen  lds
    s_add_u32 m0, s51, 3168
    s_nop 0
    buffer_load_dwordx4 v4, s[12:15], s97 offen  lds
    s_branch back_13
far_20:
    v_cvt_f32_u32 v23, v22
    v_mul_f32 v23, 0x3d800000, v23
    v_lshlrev_b32 v26, 4, v25
    v_cmp_eq_u32 s[84:85], 0, v22
    v_and_b32 v28, 1, v22
    v_cmp_eq_u32 s[86:87], 1, v28
    v_mul_f32 v27, v23, v24
    v_cos_f32 v30, v27
    v_sin_f32 v31, v27
    v_mul_f32 v30, 2.0, v30
    v_mul_f32 v31, -2.0, v31
    v_cndmask_b32 v30, v30, 1.0, s[84:85]
    v_cndmask_b32 v31, v31, 1.0, s[84:85]
    v_cvt_pk_bf16_f32 v29, v30, 0
    v_lshlrev_b32 v29, v26, v29
    v_cndmask_b32 v232, v29, 0, s[86:87]
    v_cndmask_b32 v233, 0, v29, s[86:87]
    v_cvt_pk_bf16_f32 v29, v31, 0
    v_lshlrev_b32 v29, v26, v29
    v_cndmask_b32 v238, v29, 0, s[86:87]
    v_cndmask_b32 v239, 0, v29, s[86:87]
    v_add_f32 v27, v27, v23
    v_cos_f32 v30, v27
    v_sin_f32 v31, v27
    v_mul_f32 v30, 2.0, v30
    v_mul_f32 v31, -2.0, v31
    v_cndmask_b32 v30, v30, 1.0, s[84:85]
    v_cndmask_b32 v31, v31, -1.0, s[84:85]
    v_cvt_pk_bf16_f32 v29, v30, 0
    v_lshlrev_b32 v29, v26, v29
    v_cndmask_b32 v234, v29, 0, s[86:87]
    v_cndmask_b32 v235, 0, v29, s[86:87]
    v_cvt_pk_bf16_f32 v29, v31, 0
    v_lshlrev_b32 v29, v26, v29
    v_cndmask_b32 v240, v29, 0, s[86:87]
    v_cndmask_b32 v241, 0, v29, s[86:87]
    v_add_f32 v27, v27, v23
    v_cmp_eq_u32 s[88:89], 0, v2
    v_cmp_eq_u32 s[90:91], 1, v25
    v_lshlrev_b32 v28, 31, v22
    v_xor_b32 v28, 0x34800000, v28
    v_mov_b32 v26, 0x34800000
    v_mul_f32 v27, v23, v24
    v_cos_f32 v30, v27
    v_sin_f32 v31, v27
    v_mul_f32 v30, 0x35000000, v30
    v_mul_f32 v31, 0xb5000000, v31
    v_cndmask_b32 v30, v30, v26, s[88:89]
    v_cndmask_b32 v31, v31, v28, s[88:89]
    v_cvt_pk_bf16_f32 v29, v31, v30
    v_cndmask_b32 v29, v29, 0, s[90:91]
    v_mov_b32 v244, 0
    v_mov_b32 v245, v29
    v_mov_b32 v248, v29
    v_mov_b32 v249, 0
    v_add_f32 v27, v27, v23
    v_cos_f32 v30, v27
    v_sin_f32 v31, v27
    v_mul_f32 v30, 0x35000000, v30
    v_mul_f32 v31, 0xb5000000, v31
    v_cvt_pk_bf16_f32 v29, v31, v30
    v_cndmask_b32 v29, 0, v29, s[90:91]
    v_mov_b32 v246, 0
    v_mov_b32 v247, v29
    v_mov_b32 v250, v29
    v_mov_b32 v251, 0
    v_add_f32 v27, v27, v23
    s_branch back_21
far_24:
    ds_read_u16_d16_hi v200, v16 offset:0
    ds_read_u16_d16_hi v216, v16 offset:1056
    ds_read_u16_d16_hi v201, v16 offset:64
    ds_read_u16_d16_hi v217, v16 offset:1120
    ds_read_u16_d16_hi v202, v16 offset:512
    ds_read_u16_d16_hi v218, v16 offset:1568
    ds_read_u16_d16_hi v203, v16 offset:576
    ds_read_u16_d16_hi v219, v16 offset:1632
    ds_read_u16_d16_hi v204, v16 offset:256
    ds_read_u16_d16_hi v220, v16 offset:1312
    ds_read_u16_d16_hi v205, v16 offset:320
    ds_read_u16_d16_hi v221, v16 offset:1376
    ds_read_u16_d16_hi v206, v16 offset:768
    ds_read_u16_d16_hi v222, v16 offset:1824
    ds_read_u16_d16_hi v207, v16 offset:832
    ds_read_u16_d16_hi v223, v16 offset:1888
    ds_read_u16_d16_hi v208, v17 offset:2944
    ds_read_u16_d16_hi v224, v17 offset:4000
    ds_read_u16_d16_hi v209, v17 offset:2880
    ds_read_u16_d16_hi v225, v17 offset:3936
    ds_read_u16_d16_hi v210, v17 offset:2432
    ds_read_u16_d16_hi v226, v17 offset:3488
    ds_read_u16_d16_hi v211, v17 offset:2368
    ds_read_u16_d16_hi v227, v17 offset:3424
    ds_read_u16_d16_hi v212, v17 offset:2688
    ds_read_u16_d16_hi v228, v17 offset:3744
    ds_read_u16_d16_hi v213, v17 offset:2624
    ds_read_u16_d16_hi v229, v17 offset:3680
    ds_read_u16_d16_hi v214, v17 offset:2176
    ds_read_u16_d16_hi v230, v17 offset:3232
    ds_read_u16_d16_hi v215, v17 offset:2112
    ds_read_u16_d16_hi v231, v17 offset:3168
    ds_read_u16_d16_hi v48, v16 offset:2112
    ds_read_u16_d16_hi v64, v16 offset:3168
    ds_read_u16_d16_hi v49, v16 offset:2176
    ds_read_u16_d16_hi v65, v16 offset:3232
    ds_read_u16_d16_hi v50, v16 offset:2624
    ds_read_u16_d16_hi v66, v16 offset:3680
    ds_read_u16_d16_hi v51, v16 offset:2688
    ds_read_u16_d16_hi v67, v16 offset:3744
    ds_read_u16_d16_hi v52, v16 offset:2368
    ds_read_u16_d16_hi v68, v16 offset:3424
    ds_read_u16_d16_hi v53, v16 offset:2432
    ds_read_u16_d16_hi v69, v16 offset:3488
    ds_read_u16_d16_hi v54, v16 offset:2880
    ds_read_u16_d16_hi v70, v16 offset:3936
    ds_read_u16_d16_hi v55, v16 offset:2944
    ds_read_u16_d16_hi v71, v16 offset:4000
    ds_read_u16_d16_hi v56, v17 offset:832
    ds_read_u16_d16_hi v72, v17 offset:1888
    ds_read_u16_d16_hi v57, v17 offset:768
    ds_read_u16_d16_hi v73, v17 offset:1824
    ds_read_u16_d16_hi v58, v17 offset:320
    ds_read_u16_d16_hi v74, v17 offset:1376
    ds_read_u16_d16_hi v59, v17 offset:256
    ds_read_u16_d16_hi v75, v17 offset:1312
    ds_read_u16_d16_hi v60, v17 offset:576
    ds_read_u16_d16_hi v76, v17 offset:1632
    ds_read_u16_d16_hi v61, v17 offset:512
    ds_read_u16_d16_hi v77, v17 offset:1568
    ds_read_u16_d16_hi v62, v17 offset:64
    ds_read_u16_d16_hi v78, v17 offset:1120
    ds_read_u16_d16_hi v63, v17 offset:0
    ds_read_u16_d16_hi v79, v17 offset:1056
    s_waitcnt lgkmcnt(0) vmcnt(0)
stub_8:
    s_cbranch_execz ret_1
    v_readlane_b32 s84, v252, 0
    v_readlane_b32 s85, v253, 0
    v_readlane_b32 s86, v252, 1
    v_readlane_b32 s87, v253, 1
    v_readlane_b32 s88, v252, 2
    v_readlane_b32 s89, v253, 2
    v_readlane_b32 s90, v252, 3
    v_readlane_b32 s91, v253, 3
    s_mov_b64 exec, 1
    v_mov_b32 v216, 0
    v_mov_b32 v224, 0
    v_mov_b32 v64, 0
    v_mov_b32 v72, 0
    v_mov_b32 v208, s90
    v_mov_b32 v56, s88
    s_mov_b64 exec, -1
    v_add_f32 v200, v200, v48
    v_fma_f32 v48, -2.0, v48, v200
    v_add_f32 v201, v201, v49
    v_fma_f32 v49, -2.0, v49, v201
    v_add_f32 v202, v202, v50
    v_fma_f32 v50, -2.0, v50, v202
    v_add_f32 v203, v203, v51
    v_fma_f32 v51, -2.0, v51, v203
    v_add_f32 v204, v204, v52
    v_fma_f32 v52, -2.0, v52, v204
    v_add_f32 v205, v205, v53
    v_fma_f32 v53, -2.0, v53, v205
    v_add_f32 v206, v206, v54
    v_fma_f32 v54, -2.0, v54, v206
    v_add_f32 v207, v207, v55
    v_fma_f32 v55, -2.0, v55, v207
    v_add_f32 v208, v208, v56
    v_fma_f32 v56, 2.0, v56, -v208
    v_add_f32 v209, v209, v57
    v_fma_f32 v57, 2.0, v57, -v209
    v_add_f32 v210, v210, v58
    v_fma_f32 v58, 2.0, v58, -v210
    v_add_f32 v211, v211, v59
    v_fma_f32 v59, 2.0, v59, -v211
    v_add_f32 v212, v212, v60
    v_fma_f32 v60, 2.0, v60, -v212
    v_add_f32 v213, v213, v61
    v_fma_f32 v61, 2.0, v61, -v213
    v_add_f32 v214, v214, v62
    v_fma_f32 v62, 2.0, v62, -v214
    v_add_f32 v215, v215, v63
    v_fma_f32 v63, 2.0, v63, -v215
    v_add_f32 v216, v216, v64
    v_fma_f32 v64, -2.0, v64, v216
    v_add_f32 v217, v217, v65
    v_fma_f32 v65, -2.0, v65, v217
    v_add_f32 v218, v218, v66
    v_fma_f32 v66, -2.0, v66, v218
    v_add_f32 v219, v219, v67
    v_fma_f32 v67, -2.0, v67, v219
    v_add_f32 v220, v220, v68
    v_fma_f32 v68, -2.0, v68, v220
    v_add_f32 v221, v221, v69
    v_fma_f32 v69, -2.0, v69, v221
    v_add_f32 v222, v222, v70
    v_fma_f32 v70, -2.0, v70, v222
    v_add_f32 v223, v223, v71
    v_fma_f32 v71, -2.0, v71, v223
    v_add_f32 v224, v224, v72
    v_fma_f32 v72, 2.0, v72, -v224
    v_add_f32 v225, v225, v73
    v_fma_f32 v73, 2.0, v73, -v225
    v_add_f32 v226, v226, v74
    v_fma_f32 v74, 2.0, v74, -v226
    v_add_f32 v227, v227, v75
    v_fma_f32 v75, 2.0, v75, -v227
    v_add_f32 v228, v228, v76
    v_fma_f32 v76, 2.0, v76, -v228
    v_add_f32 v229, v229, v77
    v_fma_f32 v77, 2.0, v77, -v229
    v_add_f32 v230, v230, v78
    v_fma_f32 v78, 2.0, v78, -v230
    v_add_f32 v231, v231, v79
    v_fma_f32 v79, 2.0, v79, -v231
    v_add_u32 v23, 118272, v4
    ds_write_b128 v23, v[48:51] offset:0
    ds_write_b128 v23, v[52:55] offset:1024
    ds_write_b128 v23, v[56:59] offset:2048
    ds_write_b128 v23, v[60:63] offset:3072
    ds_write_b128 v23, v[64:67] offset:4096
    ds_write_b128 v23, v[68:71] offset:5120
    ds_write_b128 v23, v[72:75] offset:6144
    ds_write_b128 v23, v[76:79] offset:7168
    v_and_b32 v22, 17, v1
    v_bfe_u32 v29, v1, 2, 2
    v_lshl_add_u32 v22, v29, 1, v22
    v_and_b32 v29, 2, v1
    v_lshl_add_u32 v22, v29, 2, v22
    v_lshrrev_b32 v23, 5, v1
    v_lshlrev_b32 v23, 9, v23
    v_lshl_add_u32 v24, v22, 2, v23
    v_add_u32 v16, 99840, v24
    v_sub_u32 v26, 32, v22
    v_lshrrev_b32 v27, 5, v26
    v_and_b32 v26, 31, v26
    v_lshlrev_b32 v26, 2, v26
    v_lshl_add_u32 v26, v27, 8, v26
    v_sub_u32 v26, v26, v23
    v_add_u32 v17, 100352, v26
    s_branch back_25
far_26:
    s_setprio 1
    v_add_u32 v30, 118272, v4
    ds_read_b128 v[120:123], v30 offset:0
    ds_read_b128 v[124:127], v30 offset:1024
    ds_read_b128 v[128:131], v30 offset:2048
    ds_read_b128 v[132:135], v30 offset:3072
    ds_read_b128 v[232:235], v30 offset:4096
    ds_read_b128 v[236:239], v30 offset:5120
    ds_read_b128 v[240:243], v30 offset:6144
    ds_read_b128 v[252:255], v30 offset:7168
    ds_write2st64_b32 v16, v80, v81 offset0:0 offset1:1
    ds_write2st64_b32 v16, v82, v83 offset0:8 offset1:9
    ds_write2st64_b32 v16, v96, v97 offset0:36 offset1:37
    ds_write2st64_b32 v16, v98, v99 offset0:44 offset1:45
    ds_write2st64_b32 v16, v80, v96 offset0:32 offset1:68
    ds_write2st64_b32 v16, v84, v85 offset0:4 offset1:5
    ds_write2st64_b32 v16, v86, v87 offset0:12 offset1:13
    ds_write2st64_b32 v16, v100, v101 offset0:40 offset1:41
    ds_write2st64_b32 v16, v102, v103 offset0:48 offset1:49
    v_mul_f32 v22, v80, v216
    v_mul_f32 v23, v81, v217
    v_mul_f32 v24, v82, v218
    v_mul_f32 v25, v83, v219
    v_mul_f32 v80, v80, v200
    v_mul_f32 v81, v81, v201
    v_mul_f32 v82, v82, v202
    v_mul_f32 v83, v83, v203
    v_fma_f32 v80, -v96, v216, v80
    v_fma_f32 v81, -v97, v217, v81
    v_fma_f32 v82, -v98, v218, v82
    v_fma_f32 v83, -v99, v219, v83
    v_fma_f32 v96, v96, v200, v22
    v_fma_f32 v97, v97, v201, v23
    v_fma_f32 v98, v98, v202, v24
    v_fma_f32 v99, v99, v203, v25
    ds_write2st64_b32 v16, v88, v89 offset0:16 offset1:17
    ds_write2st64_b32 v16, v90, v91 offset0:24 offset1:25
    ds_write2st64_b32 v16, v104, v105 offset0:52 offset1:53
    ds_write2st64_b32 v16, v106, v107 offset0:60 offset1:61
    ds_write2st64_b32 v16, v92, v93 offset0:20 offset1:21
    ds_write2st64_b32 v16, v94, v95 offset0:28 offset1:29
    ds_write2st64_b32 v16, v108, v109 offset0:56 offset1:57
    ds_write2st64_b32 v16, v110, v111 offset0:64 offset1:65
    ds_read2st64_b32 v[200:201], v17 offset0:29 offset1:28
    ds_read2st64_b32 v[202:203], v17 offset0:21 offset1:20
    ds_read2st64_b32 v[216:217], v17 offset0:65 offset1:64
    ds_read2st64_b32 v[218:219], v17 offset0:57 offset1:56
    v_mul_f32 v22, v84, v220
    v_mul_f32 v23, v85, v221
    v_mul_f32 v24, v86, v222
    v_mul_f32 v25, v87, v223
    v_mul_f32 v84, v84, v204
    v_mul_f32 v85, v85, v205
    v_mul_f32 v86, v86, v206
    v_mul_f32 v87, v87, v207
stub_9:
    s_cbranch_execz ret_1
    v_fma_f32 v84, -v100, v220, v84
    v_fma_f32 v85, -v101, v221, v85
    v_fma_f32 v86, -v102, v222, v86
    v_fma_f32 v87, -v103, v223, v87
    v_fma_f32 v100, v100, v204, v22
    v_fma_f32 v101, v101, v205, v23
    v_fma_f32 v102, v102, v206, v24
    v_fma_f32 v103, v103, v207, v25
    ds_read2st64_b32 v[204:205], v17 offset0:25 offset1:24
    ds_read2st64_b32 v[206:207], v17 offset0:17 offset1:16
    ds_read2st64_b32 v[220:221], v17 offset0:61 offset1:60
    ds_read2st64_b32 v[222:223], v17 offset0:53 offset1:52
    v_mul_f32 v22, v88, v224
    v_mul_f32 v23, v89, v225
    v_mul_f32 v24, v90, v226
    v_mul_f32 v25, v91, v227
    v_mul_f32 v88, v88, v208
    v_mul_f32 v89, v89, v209
    v_mul_f32 v90, v90, v210
    v_mul_f32 v91, v91, v211
    v_fma_f32 v88, v104, v224, v88
    v_fma_f32 v89, v105, v225, v89
    v_fma_f32 v90, v106, v226, v90
    v_fma_f32 v91, v107, v227, v91
    v_fma_f32 v104, v104, v208, -v22
    v_fma_f32 v105, v105, v209, -v23
    v_fma_f32 v106, v106, v210, -v24
    v_fma_f32 v107, v107, v211, -v25
    ds_read2st64_b32 v[208:209], v17 offset0:13 offset1:12
    ds_read2st64_b32 v[210:211], v17 offset0:5 offset1:4
    ds_read2st64_b32 v[224:225], v17 offset0:49 offset1:48
    ds_read2st64_b32 v[226:227], v17 offset0:41 offset1:40
    v_mul_f32 v22, v92, v228
    v_mul_f32 v23, v93, v229
    v_mul_f32 v24, v94, v230
    v_mul_f32 v25, v95, v231
    v_mul_f32 v92, v92, v212
    v_mul_f32 v93, v93, v213
    v_mul_f32 v94, v94, v214
    v_mul_f32 v95, v95, v215
    v_fma_f32 v92, v108, v228, v92
    v_fma_f32 v93, v109, v229, v93
    v_fma_f32 v94, v110, v230, v94
    v_fma_f32 v95, v111, v231, v95
    v_fma_f32 v108, v108, v212, -v22
    v_fma_f32 v109, v109, v213, -v23
    v_fma_f32 v110, v110, v214, -v24
    v_fma_f32 v111, v111, v215, -v25
    ds_read2st64_b32 v[212:213], v17 offset0:9 offset1:8
    ds_read2st64_b32 v[214:215], v17 offset0:1 offset1:0
    ds_read2st64_b32 v[228:229], v17 offset0:45 offset1:44
    ds_read2st64_b32 v[230:231], v17 offset0:37 offset1:36
    s_waitcnt lgkmcnt(12)
    v_fmac_f32 v80, v200, v120
    v_fmac_f32 v81, v201, v121
    v_fmac_f32 v82, v202, v122
    v_fmac_f32 v83, v203, v123
    v_fma_f32 v96, -v216, v120, v96
    v_fma_f32 v97, -v217, v121, v97
    v_fma_f32 v98, -v218, v122, v98
    v_fma_f32 v99, -v219, v123, v99
    v_fma_f32 v80, v216, v232, v80
    v_fma_f32 v81, v217, v233, v81
    v_fma_f32 v82, v218, v234, v82
    v_fma_f32 v83, v219, v235, v83
    v_fma_f32 v96, v200, v232, v96
    v_fma_f32 v97, v201, v233, v97
    v_fma_f32 v98, v202, v234, v98
    v_fma_f32 v99, v203, v235, v99
    v_cvt_pk_bf16_f32 v32, v96, v80
    v_cvt_pk_bf16_f32 v33, v97, v81
    v_cvt_pk_bf16_f32 v34, v98, v82
    v_cvt_pk_bf16_f32 v35, v99, v83
    s_waitcnt lgkmcnt(8)
    v_fmac_f32 v84, v204, v124
    v_fmac_f32 v85, v205, v125
    v_fmac_f32 v86, v206, v126
    v_fmac_f32 v87, v207, v127
    v_fma_f32 v100, -v220, v124, v100
    v_fma_f32 v101, -v221, v125, v101
    v_fma_f32 v102, -v222, v126, v102
    v_fma_f32 v103, -v223, v127, v103
    v_mfma_f32_32x32x16_bf16 v[48:63], v[32:35], v[136:139], 0
    v_fma_f32 v84, v220, v236, v84
    v_fma_f32 v85, v221, v237, v85
    v_fma_f32 v86, v222, v238, v86
    v_fma_f32 v87, v223, v239, v87
    v_fma_f32 v100, v204, v236, v100
    v_fma_f32 v101, v205, v237, v101
    v_fma_f32 v102, v206, v238, v102
    v_fma_f32 v103, v207, v239, v103
    v_mfma_f32_32x32x16_bf16 v[64:79], v[32:35], v[152:155], 0
    v_cvt_pk_bf16_f32 v36, v100, v84
    v_cvt_pk_bf16_f32 v37, v101, v85
    v_cvt_pk_bf16_f32 v38, v102, v86
    v_cvt_pk_bf16_f32 v39, v103, v87
    s_waitcnt lgkmcnt(4)
    v_fmac_f32 v88, v208, v128
    v_fmac_f32 v89, v209, v129
    v_fmac_f32 v90, v210, v130
    v_fmac_f32 v91, v211, v131
    v_fma_f32 v104, -v224, v128, v104
    v_fma_f32 v105, -v225, v129, v105
    v_fma_f32 v106, -v226, v130, v106
    v_fma_f32 v107, -v227, v131, v107
    v_mfma_f32_32x32x16_bf16 v[48:63], v[36:39], v[140:143], v[48:63]
    v_fma_f32 v88, -v224, v240, v88
    v_fma_f32 v89, -v225, v241, v89
    v_fma_f32 v90, -v226, v242, v90
    v_fma_f32 v91, -v227, v243, v91
    v_fma_f32 v104, -v208, v240, v104
    v_fma_f32 v105, -v209, v241, v105
    v_fma_f32 v106, -v210, v242, v106
    v_fma_f32 v107, -v211, v243, v107
    v_mfma_f32_32x32x16_bf16 v[64:79], v[36:39], v[156:159], v[64:79]
    v_cvt_pk_bf16_f32 v40, v104, v88
    v_cvt_pk_bf16_f32 v41, v105, v89
    v_cvt_pk_bf16_f32 v42, v106, v90
    v_cvt_pk_bf16_f32 v43, v107, v91
    s_waitcnt lgkmcnt(0)
    v_fmac_f32 v92, v212, v132
    v_fmac_f32 v93, v213, v133
    v_fmac_f32 v94, v214, v134
    v_fmac_f32 v95, v215, v135
    v_fma_f32 v108, -v228, v132, v108
    v_fma_f32 v109, -v229, v133, v109
    v_fma_f32 v110, -v230, v134, v110
    v_fma_f32 v111, -v231, v135, v111
    v_mfma_f32_32x32x16_bf16 v[48:63], v[40:43], v[144:147], v[48:63]
    v_fma_f32 v92, -v228, v252, v92
    v_fma_f32 v93, -v229, v253, v93
    v_fma_f32 v94, -v230, v254, v94
    v_fma_f32 v95, -v231, v255, v95
    v_fma_f32 v108, -v212, v252, v108
    v_fma_f32 v109, -v213, v253, v109
    v_fma_f32 v110, -v214, v254, v110
    v_fma_f32 v111, -v215, v255, v111
    v_mfma_f32_32x32x16_bf16 v[64:79], v[40:43], v[160:163], v[64:79]
    v_cvt_pk_bf16_f32 v44, v108, v92
    v_cvt_pk_bf16_f32 v45, v109, v93
    v_cvt_pk_bf16_f32 v46, v110, v94
    v_cvt_pk_bf16_f32 v47, v111, v95
    s_nop 1
    v_mfma_f32_32x32x16_bf16 v[48:63], v[44:47], v[148:151], v[48:63]
    v_mfma_f32_32x32x16_bf16 v[64:79], v[44:47], v[164:167], v[64:79]
    s_branch back_27
.fill 64, 4, 0xbf810000
.section .rodata,"a"
.p2align 6
.amdhsa_kernel concat_heads__spectral_gfnet__spectral_gfnet__prompt_kernel
  .amdhsa_next_free_vgpr 256
  .amdhsa_next_free_sgpr 102
  .amdhsa_accum_offset 256
  .amdhsa_group_segment_fixed_size 0
  .amdhsa_kernarg_size 72
  .amdhsa_user_sgpr_count 2
  .amdhsa_user_sgpr_kernarg_segment_ptr 1
  .amdhsa_system_sgpr_workgroup_id_x 1
.end_amdhsa_kernel
```
